```python
import torch

def _softmax(x, axis=-1):
    return torch.softmax(x, dim=axis)
def _gelu(x):
    return torch.nn.functional.gelu(x, approximate="tanh")
def _silu(x):
    return torch.nn.functional.silu(x)
def _sigmoid(x):
    return torch.sigmoid(x)
def _layernorm(x, axis=-1, eps=1e-5):
    m = x.mean(dim=axis, keepdim=True)
    v = x.var(dim=axis, keepdim=True, unbiased=False)
    return (x - m) / torch.sqrt(v + eps)
def _scatter_add(tgt, idx, src, axis=0):
    return tgt.clone().index_add_(axis, idx, src)
def _segment_sum(src, seg, n):
    out = torch.zeros((n,) + src.shape[1:], dtype=src.dtype)
    return out.index_add_(0, seg, src)
def _pad(x, pw):
    flat = tuple(v for pair in reversed(pw) for v in pair)
    return torch.nn.functional.pad(x, flat)

kernel_name = 'sequential_preLN__gqa_block_cached__glu_gated_swiglu__decode'

def setup_inputs():

    _w = (lambda a: (lambda t: t.to(torch.bfloat16) if t.is_floating_point() else t)(torch.as_tensor(a)))
    def _A_setup():
        B, Sq, D = 1, 1, 512
        Hq, Hkv, Sk, Dh = 32, 8, 65536, 128
        assert Hq % Hkv == 0, (Hq, Hkv)
        return {
            "x": _w((lambda *s: torch.randn(*s, dtype=torch.bfloat16) * 0.05)(B, Sq, D)),
            "k_cache": _w((lambda *s: torch.randn(*s, dtype=torch.bfloat16) * 3.2)(B, Hkv, Sk, Dh)),
            "v_cache": _w((lambda *s: torch.randn(*s, dtype=torch.bfloat16) * 1.6)(B, Hkv, Sk, Dh)),
            "wq": _w((lambda *s: torch.randn(*s, dtype=torch.bfloat16) * 3.2)(D, Hq * Dh) * (D ** -0.5)),
            "wo": _w((lambda *s: torch.randn(*s, dtype=torch.bfloat16) * 1.6)(Hq * Dh, D) * ((Hq * Dh) ** -0.5)),
        }
    _A_in = _A_setup()

    def _B_setup():
        B, S, D, F = 1, 1, 512, 1792
        return {
            "x": _w((lambda *s: torch.randn(*s, dtype=torch.bfloat16) * 0.05)(B, S, D)),
            "w1": _w((lambda *s: torch.randn(*s, dtype=torch.bfloat16) * 1.6)(D, F) * (2.0 / D) ** 0.5),
            "w3": _w((lambda *s: torch.randn(*s, dtype=torch.bfloat16) * 1.6)(D, F) * (2.0 / D) ** 0.5),
            "w2": _w((lambda *s: torch.randn(*s, dtype=torch.bfloat16) * 1.6)(F, D) * (2.0 / F) ** 0.5),
        }
    _B_in = _B_setup()

    return {
        "A_x": _A_in["x"],
        "A_k_cache": _A_in["k_cache"],
        "A_v_cache": _A_in["v_cache"],
        "A_wq": _A_in["wq"],
        "A_wo": _A_in["wo"],
        "B_x": _B_in["x"],
        "B_w1": _B_in["w1"],
        "B_w3": _B_in["w3"],
        "B_w2": _B_in["w2"],
    }

def reference(A_x, A_k_cache, A_v_cache, A_wq, A_wo, B_x, B_w1, B_w3, B_w2):
    def _A_ref(x, k_cache, v_cache, wq, wo):
        B, Sq, D = x.shape
        Hq, Dh = 32, 128
        Hkv = k_cache.shape[1]
        rep = Hq // Hkv
        q = (lambda x, *d: x.permute(*d))((x @ wq).reshape(B, Sq, Hq, Dh), 0, 2, 1, 3)
        k = (lambda x, n, axis: torch.repeat_interleave(x, n, dim=axis))(k_cache, rep, axis=1)
        v = (lambda x, n, axis: torch.repeat_interleave(x, n, dim=axis))(v_cache, rep, axis=1)
        scores = torch.einsum("bhqd,bhkd->bhqk", q, k) * (Dh ** -0.5)
        p = _softmax(scores, axis=-1)
        o = torch.einsum("bhqk,bhkd->bhqd", p, v)
        return (lambda x, *d: x.permute(*d))(o, 0, 2, 1, 3).reshape(B, Sq, Hq * Dh) @ wo

    def _B_ref(x, w1, w3, w2):
        gate = torch.einsum("bsd,df->bsf", x, w1)
        up = torch.einsum("bsd,df->bsf", x, w3)
        h = _silu(gate) * up
        out = torch.einsum("bsf,fd->bsd", h, w2)
        return out

    x = A_x
    h = x + _A_ref(_layernorm(x, axis=-1), A_k_cache, A_v_cache, A_wq, A_wo)
    h2 = h + _B_ref(_layernorm(h, axis=-1), B_w1, B_w3, B_w2)
    return h2
```

```asm
; @launch grid=(256,1,1) block=(512,1,1) lds=155136
.amdgcn_target "amdgcn-amd-amdhsa--gfx950"
.text
.globl sequential_preLN__gqa_block_cached__glu_gated_swiglu__decode_kernel
.p2align 8
.type sequential_preLN__gqa_block_cached__glu_gated_swiglu__decode_kernel,@function
sequential_preLN__gqa_block_cached__glu_gated_swiglu__decode_kernel:
  s_cmp_ge_u32 s2, 256
  s_cbranch_scc1 L_done
  s_load_dwordx8 s[44:51], s[0:1], 0
  s_load_dwordx2 s[12:13], s[0:1], 88
  s_load_dwordx2 s[52:53], s[0:1], 32
  s_load_dwordx8 s[56:63], s[0:1], 48
  s_getpc_b64 s[16:17]
L_pc:
  s_sub_u32 s16, s16, L_pc-sequential_preLN__gqa_block_cached__glu_gated_swiglu__decode_kernel
  s_subb_u32 s17, s17, 0
  v_lshlrev_b32 v23, 4, v0
  global_load_dwordx4 v[88:91], v23, s[16:17]
  v_add_u32 v23, 0x2000, v23
  v_min_u32 v23, L_codeend-sequential_preLN__gqa_block_cached__glu_gated_swiglu__decode_kernel-16, v23
  global_load_dwordx4 v[92:95], v23, s[16:17]
  v_and_b32 v1, 63, v0
  v_lshrrev_b32 v14, 6, v0
  s_nop 0
  v_readfirstlane_b32 s3, v14
  v_lshlrev_b32 v2, 4, v1
  s_lshr_b32 s18, s2, 5
  s_and_b32 s19, s2, 31
  s_lshr_b32 s21, s2, 3
  s_and_b32 s32, s2, 7
  s_cmp_eq_u32 s32, 0
  s_cselect_b32 s20, 1, 0
  s_movk_i32 s33, 133
  s_cselect_b32 s33, 93, s33
  v_lshrrev_b32 v17, 3, v1
  v_and_b32 v18, 7, v1
  s_lshr_b32 s35, s32, 1
  s_and_b32 s55, s32, 1
  s_lshl_b32 s55, s55, 2
  s_lshr_b32 s36, s19, 3
  s_or_b32 s55, s55, s36
  s_lshl_b32 s34, s35, 6
  s_lshl_b32 s36, s3, 3
  s_add_u32 s34, s34, s36
  v_add_u32 v16, s34, v17
  v_lshlrev_b32 v15, 14, v16
  v_lshl_add_u32 v15, v18, 4, v15
  v_lshlrev_b32 v16, 2, v16
  s_lshl_b32 s34, s18, 10
  s_lshl_b32 s36, s55, 7
  s_add_u32 s34, s34, s36
  v_add_u32 v15, s34, v15
  v_add_u32 v19, 0x2000, v15
  s_lshl_b32 s54, s18, 14
  s_lshl_b32 s35, s35, 12
  s_add_u32 s54, s54, s35
  s_lshl_b32 s35, s55, 9
  s_add_u32 s54, s54, s35
  s_add_u32 s54, s54, 1048576
  v_lshrrev_b32 v20, 4, v1
  v_and_b32 v21, 15, v1
  v_xor_b32 v22, v20, v21
  v_lshlrev_b32 v22, 4, v22
  v_lshl_add_u32 v3, v20, 8, v22
  v_xor_b32 v4, 64, v3
  v_xor_b32 v5, 128, v3
  v_xor_b32 v6, 192, v3
  s_lshr_b32 s34, s2, 3
  s_and_b32 s34, s34, 3
  s_andn2_b32 s35, s2, 31
  s_or_b32 s34, s34, s35
  s_lshl_b32 s40, s34, 19
  s_lshl_b32 s35, s32, 2
  s_or_b32 s34, s34, s35
  s_lshl_b32 s25, s34, 19
  s_cmp_eq_u32 s20, 1
  s_cselect_b32 s15, 0, 5
  s_cselect_b32 s34, 35, -5
  s_mul_i32 s35, s2, 8
  s_add_u32 s14, s34, s35
  s_andn2_b32 s34, s2, 7
  s_mul_i32 s34, s34, 8
  s_mul_i32 s35, s32, 5
  s_add_u32 s34, s34, s35
  s_sub_u32 s17, s34, 53
  s_mov_b32 s22, s33
  s_lshl_b32 s23, s33, 1
  s_lshl_b32 s28, s3, 14
  s_mov_b32 s26, s28
  s_mov_b32 s27, s28
  s_mov_b32 s24, s3
  s_mov_b32 s6, 0x8000000
  s_mov_b32 s7, 0x20000
  s_mov_b32 s10, 0x8000000
  s_mov_b32 s11, 0x20000
  s_waitcnt lgkmcnt(0)
  global_load_dwordx4 v[80:83], v2, s[44:45]
  global_load_dword v84, v16, s[44:45]
  global_load_dwordx4 v[32:35], v15, s[50:51] nt
  global_load_dwordx4 v[36:39], v19, s[50:51] nt
  s_load_dword s29, s[12:13], 0
  s_mov_b32 s4, s46
  s_and_b32 s5, s47, 0xffff
  s_mov_b32 s8, s48
  s_and_b32 s9, s49, 0xffff
  s_mov_b64 s[50:51], s[44:45]
  s_barrier
  s_cmp_eq_u32 s20, 1
  s_cbranch_scc1 L_tburst
  s_cmp_lt_u32 s24, 48
  s_cselect_b32 s35, s15, 0
  s_add_u32 s36, s35, s14
  s_sub_u32 s35, s24, 48
  s_cmp_lt_u32 s35, s15
  s_cselect_b32 s35, s40, s25
  s_cselect_b32 s36, s17, s36
  s_add_u32 s34, s24, s36
  s_and_b32 s34, s34, 127
  s_lshl_b32 s34, s34, 12
  s_add_u32 s34, s34, s35
  s_mov_b32 m0, s27
  s_nop 0
  buffer_load_dwordx4 v3, s[4:7], s34 offen offset:0 nt lds
  buffer_load_dwordx4 v4, s[4:7], s34 offen offset:1024 nt lds
  buffer_load_dwordx4 v5, s[4:7], s34 offen offset:2048 nt lds
  buffer_load_dwordx4 v6, s[4:7], s34 offen offset:3072 nt lds
  s_add_u32 s24, s24, 8
  s_add_u32 s27, s27, 4096
  s_and_b32 s27, s27, 0x3fff
  s_or_b32 s27, s27, s28
L_tburstret:
  v_lshlrev_b32 v8, 8, v21
  v_add_u32 v8, v8, v22
  v_lshlrev_b32 v9, 10, v20
  v_lshl_add_u32 v9, v21, 3, v9
  v_bfe_u32 v23, v1, 1, 2
  v_lshlrev_b32 v7, 8, v23
  v_lshl_add_u32 v7, v17, 5, v7
  v_and_b32 v23, 1, v1
  v_lshl_add_u32 v7, v23, 4, v7
  s_mul_i32 s34, s3, 2560
  s_add_u32 s34, s34, 131072
  v_and_b32 v23, 3, v1
  v_lshl_add_u32 v24, v20, 2, v23
  v_lshlrev_b32 v24, 3, v24
  v_add_u32 v10, 131072, v24
  v_add_u32 v11, s34, v24
  v_bfe_u32 v24, v1, 2, 2
  v_lshl_add_u32 v11, v24, 7, v11
  v_mov_b32 v30, 152976
  v_mov_b32 v31, 32
  ds_write_b32 v30, v31
  v_mov_b32 v24, 0xff80ff80
  v_mov_b32 v25, 0xff80ff80
  ds_write_b64 v11, v[24:25] offset:0
  ds_write_b64 v11, v[24:25] offset:512
  ds_write_b64 v11, v[24:25] offset:1024
  ds_write_b64 v11, v[24:25] offset:1536
  ds_write_b64 v11, v[24:25] offset:2048
  v_lshrrev_b32 v26, 5, v1
  v_lshlrev_b32 v29, 3, v18
  v_lshl_add_u32 v29, v26, 2, v29
  v_bfe_u32 v26, v1, 4, 1
  v_lshl_add_u32 v29, v26, 1, v29
  v_bfe_u32 v26, v1, 3, 1
  v_add_u32 v29, v26, v29
  s_lshl_b32 s34, s3, 2
  s_add_u32 s34, s34, 153088
  v_lshl_add_u32 v29, v29, 5, s34
  s_mov_b32 s37, 0x05040100
  s_mov_b32 s38, 0x07060302
  s_movk_i32 s39, 0xff
  s_mov_b32 s31, 400000
  s_mov_b32 s41, 0
  s_sub_u32 s34, s23, 24
  s_cmp_eq_u32 s3, 0
  s_cselect_b32 s42, s34, -1
  s_getreg_b32 s43, hwreg(HW_REG_XCC_ID, 0, 4)
  s_waitcnt vmcnt(7)
  v_lshlrev_b32 v14, 16, v80
  v_and_b32 v15, 0xffff0000, v80
  v_lshlrev_b32 v16, 16, v81
  v_and_b32 v17, 0xffff0000, v81
  v_lshlrev_b32 v18, 16, v82
  v_and_b32 v19, 0xffff0000, v82
  v_lshlrev_b32 v20, 16, v83
  v_and_b32 v21, 0xffff0000, v83
  v_readfirstlane_b32 s36, v14
  s_nop 1
  v_subrev_f32 v22, s36, v15
  v_subrev_f32 v24, s36, v14
  v_mul_f32 v23, v22, v22
  v_add_f32 v22, v22, v24
  v_fmac_f32 v23, v24, v24
  v_subrev_f32 v25, s36, v16
  v_add_f32 v22, v22, v25
  v_fmac_f32 v23, v25, v25
  v_subrev_f32 v24, s36, v17
  v_add_f32 v22, v22, v24
  v_fmac_f32 v23, v24, v24
  v_subrev_f32 v25, s36, v18
  v_add_f32 v22, v22, v25
  v_fmac_f32 v23, v25, v25
  v_subrev_f32 v24, s36, v19
  v_add_f32 v22, v22, v24
  v_fmac_f32 v23, v24, v24
  v_subrev_f32 v25, s36, v20
  v_add_f32 v22, v22, v25
  v_fmac_f32 v23, v25, v25
  v_subrev_f32 v24, s36, v21
  v_add_f32 v22, v22, v24
  v_fmac_f32 v23, v24, v24
  s_nop 0
  v_add_f32_dpp v22, v22, v22 quad_perm:[1,0,3,2] row_mask:0xf bank_mask:0xf
  v_add_f32_dpp v23, v23, v23 quad_perm:[1,0,3,2] row_mask:0xf bank_mask:0xf
  s_nop 0
  v_add_f32_dpp v22, v22, v22 quad_perm:[2,3,0,1] row_mask:0xf bank_mask:0xf
  v_add_f32_dpp v23, v23, v23 quad_perm:[2,3,0,1] row_mask:0xf bank_mask:0xf
  s_nop 0
  v_add_f32_dpp v22, v22, v22 row_half_mirror row_mask:0xf bank_mask:0xf
  v_add_f32_dpp v23, v23, v23 row_half_mirror row_mask:0xf bank_mask:0xf
  s_nop 0
  v_add_f32_dpp v22, v22, v22 row_mirror row_mask:0xf bank_mask:0xf
  v_add_f32_dpp v23, v23, v23 row_mirror row_mask:0xf bank_mask:0xf
  s_nop 0
  v_add_f32_dpp v22, v22, v22 row_bcast:15 row_mask:0xa bank_mask:0xf
  v_add_f32_dpp v23, v23, v23 row_bcast:15 row_mask:0xa bank_mask:0xf
  s_nop 0
  v_add_f32_dpp v22, v22, v22 row_bcast:31 row_mask:0xc bank_mask:0xf
  v_add_f32_dpp v23, v23, v23 row_bcast:31 row_mask:0xc bank_mask:0xf
  v_readlane_b32 s32, v22, 63
  v_readlane_b32 s33, v23, 63
  v_mov_b32 v24, 0x3b000000
  v_mul_f32 v22, s32, v24
  v_mul_f32 v23, s33, v24
  v_add_f32 v26, s36, v22
  v_fma_f32 v23, -v22, v22, v23
  v_max_f32 v23, 0, v23
  v_cvt_pk_bf16_f32 v24, v26, v23
  v_lshlrev_b32 v26, 16, v24
  v_and_b32 v23, 0xffff0000, v24
  v_add_f32 v23, 0x3727c5ac, v23
  v_cvt_pk_bf16_f32 v23, v23, v23
  v_and_b32 v23, 0xffff0000, v23
  v_sqrt_f32 v23, v23
  s_nop 0
  v_cvt_pk_bf16_f32 v27, v23, v23
  v_and_b32 v27, 0xffff0000, v27
  v_rcp_f32 v28, v27
  s_waitcnt vmcnt(6)
  v_lshlrev_b32 v14, 16, v84
  v_and_b32 v15, 0xffff0000, v84
  v_sub_f32 v14, v14, v26
  v_sub_f32 v15, v15, v26
  v_cvt_pk_bf16_f32 v84, v14, v15
  v_lshlrev_b32 v14, 16, v84
  v_and_b32 v15, 0xffff0000, v84
  v_mul_f32 v16, v14, v28
  v_mul_f32 v17, v15, v28
  v_fma_f32 v14, -v16, v27, v14
  v_fma_f32 v15, -v17, v27, v15
  v_fma_f32 v14, v14, v28, v16
  v_fma_f32 v15, v15, v28, v17
  v_cvt_pk_bf16_f32 v84, v14, v15
  s_waitcnt vmcnt(4) lgkmcnt(0)
  s_add_u32 s29, s29, 1
  s_and_b32 s30, s29, 0xff
  v_mov_b32 v13, s30
  v_perm_b32 v40, v36, v32, s37
  v_perm_b32 v41, v36, v32, s38
  v_perm_b32 v42, v37, v33, s37
  v_perm_b32 v43, v37, v33, s38
  v_perm_b32 v44, v38, v34, s37
  v_perm_b32 v45, v38, v34, s38
  v_perm_b32 v46, v39, v35, s37
  v_perm_b32 v47, v39, v35, s38
  v_dot2_f32_bf16 v14, v40, v84, 0
  v_dot2_f32_bf16 v15, v41, v84, 0
  v_dot2_f32_bf16 v16, v42, v84, 0
  v_dot2_f32_bf16 v17, v43, v84, 0
  v_dot2_f32_bf16 v18, v44, v84, 0
  v_dot2_f32_bf16 v19, v45, v84, 0
  v_dot2_f32_bf16 v20, v46, v84, 0
  v_dot2_f32_bf16 v21, v47, v84, 0
  v_permlane32_swap_b32 v14, v18
  v_permlane32_swap_b32 v15, v19
  v_permlane32_swap_b32 v16, v20
  v_permlane32_swap_b32 v17, v21
  v_add_f32 v14, v14, v18
  v_add_f32 v15, v15, v19
  v_add_f32 v16, v16, v20
  v_add_f32 v17, v17, v21
  s_nop 0
  v_permlane16_swap_b32 v14, v16
  v_permlane16_swap_b32 v15, v17
  v_add_f32 v14, v14, v16
  v_add_f32 v15, v15, v17
  s_nop 0
  v_add_f32_dpp v16, v14, v14 row_ror:8 row_mask:0xf bank_mask:0x3
  s_nop 1
  v_add_f32_dpp v16, v15, v15 row_ror:8 row_mask:0xf bank_mask:0xc
  ds_write_b32 v29, v16
  s_waitcnt lgkmcnt(0)
  s_barrier
  s_cmp_lg_u32 s3, 0
  s_cbranch_scc1 L_noq
  v_lshlrev_b32 v14, 5, v1
  v_add_u32 v14, 153088, v14
  ds_read_b128 v[32:35], v14
  ds_read_b128 v[36:39], v14 offset:16
  v_lshl_add_u32 v15, v1, 3, s54
  s_waitcnt lgkmcnt(0)
  v_pk_add_f32 v[32:33], v[32:33], v[34:35]
  v_pk_add_f32 v[36:37], v[36:37], v[38:39]
  v_pk_add_f32 v[32:33], v[32:33], v[36:37]
  v_add_f32 v32, v32, v33
  v_mov_b32 v33, s29
  global_store_dwordx2 v15, v[32:33], s[12:13] sc1
  v_lshrrev_b32 v16, 4, v1
  v_and_b32 v17, 15, v1
  s_lshl_b32 s34, s18, 15
  s_lshl_b32 s35, s19, 8
  s_add_u32 s34, s34, s35
  s_add_u32 s34, s34, 131072
  v_lshl_add_u32 v16, v16, 13, s34
  v_lshl_add_u32 v16, v17, 4, v16
  v_mov_b32 v36, -1
  v_mov_b32 v37, -1
  v_mov_b32 v38, -1
  v_mov_b32 v39, -1
  global_store_dwordx4 v16, v[36:39], s[12:13] sc1
L_noq:
  s_barrier
  s_lshl_b32 s34, s18, 14
  s_lshl_b32 s35, s3, 9
  s_add_u32 s34, s34, s35
  s_add_u32 s34, s34, 1048576
  v_lshrrev_b32 v16, 4, v1
  v_and_b32 v17, 15, v1
  v_lshl_add_u32 v14, v16, 12, s34
  v_lshl_add_u32 v14, v17, 5, v14
  s_lshl_b32 s34, s3, 7
  s_add_u32 s34, s34, 151552
  v_lshl_add_u32 v15, v17, 3, s34
  v_lshrrev_b32 v17, 1, v16
  v_and_b32 v16, 1, v16
  v_lshl_add_u32 v15, v17, 2, v15
  v_lshl_add_u32 v15, v16, 1, v15
  s_cmp_eq_u32 s20, 1
  s_cbranch_scc1 L_tailpro
  s_lshl_b32 s34, s18, 14
  s_lshl_b32 s35, s3, 9
  s_add_u32 s34, s34, s35
  s_add_u32 s34, s34, 1048576
  s_add_u32 s44, s12, s34
  s_addc_u32 s45, s13, 0
  s_mov_b32 s55, 0
  s_cmp_eq_u32 s55, 1
  s_cbranch_scc1 L_ps1q
  s_waitcnt vmcnt(3)
  s_cmp_lt_u32 s24, 48
  s_cselect_b32 s35, s15, 0
  s_add_u32 s36, s35, s14
  s_sub_u32 s35, s24, 48
  s_cmp_lt_u32 s35, s15
  s_cselect_b32 s35, s40, s25
  s_cselect_b32 s36, s17, s36
  s_add_u32 s34, s24, s36
  s_and_b32 s34, s34, 127
  s_lshl_b32 s34, s34, 12
  s_add_u32 s34, s34, s35
  s_mov_b32 m0, s27
  s_nop 0
  buffer_load_dwordx4 v3, s[4:7], s34 offen offset:0 nt lds
  buffer_load_dwordx4 v4, s[4:7], s34 offen offset:1024 nt lds
  buffer_load_dwordx4 v5, s[4:7], s34 offen offset:2048 nt lds
  buffer_load_dwordx4 v6, s[4:7], s34 offen offset:3072 nt lds
  s_add_u32 s24, s24, 8
  s_add_u32 s27, s27, 4096
  s_and_b32 s27, s27, 0x3fff
  s_or_b32 s27, s27, s28
L_ps1r:
  s_cmp_lg_u32 s55, 0
  s_cbranch_scc1 L_ps1e
  s_load_dword s64, s[44:45], 508 glc
  s_load_dword s65, s[44:45], 4604 glc
  s_load_dword s66, s[44:45], 8700 glc
  s_load_dword s67, s[44:45], 12796 glc
  s_waitcnt lgkmcnt(0)
  s_xor_b32 s64, s64, s29
  s_xor_b32 s65, s65, s29
  s_xor_b32 s66, s66, s29
  s_xor_b32 s67, s67, s29
  s_or_b32 s64, s64, s65
  s_or_b32 s66, s66, s67
  s_or_b32 s64, s64, s66
  s_cmp_eq_u32 s64, 0
  s_cbranch_scc0 L_ps1e
  global_load_dwordx4 v[40:43], v14, s[12:13] sc1
  global_load_dwordx4 v[44:47], v14, s[12:13] offset:16 sc1
  s_mov_b32 s55, 1
L_ps1e:
  s_cmp_eq_u32 s55, 1
  s_cbranch_scc1 L_ps2q
  s_waitcnt vmcnt(3)
  s_cmp_lt_u32 s24, 48
  s_cselect_b32 s35, s15, 0
  s_add_u32 s36, s35, s14
  s_sub_u32 s35, s24, 48
  s_cmp_lt_u32 s35, s15
  s_cselect_b32 s35, s40, s25
  s_cselect_b32 s36, s17, s36
  s_add_u32 s34, s24, s36
  s_and_b32 s34, s34, 127
  s_lshl_b32 s34, s34, 12
  s_add_u32 s34, s34, s35
  s_mov_b32 m0, s27
  s_nop 0
  buffer_load_dwordx4 v3, s[4:7], s34 offen offset:0 nt lds
  buffer_load_dwordx4 v4, s[4:7], s34 offen offset:1024 nt lds
  buffer_load_dwordx4 v5, s[4:7], s34 offen offset:2048 nt lds
  buffer_load_dwordx4 v6, s[4:7], s34 offen offset:3072 nt lds
  s_add_u32 s24, s24, 8
  s_add_u32 s27, s27, 4096
  s_and_b32 s27, s27, 0x3fff
  s_or_b32 s27, s27, s28
L_ps2r:
  s_cmp_lg_u32 s55, 0
  s_cbranch_scc1 L_ps2e
  s_load_dword s64, s[44:45], 508 glc
  s_load_dword s65, s[44:45], 4604 glc
  s_load_dword s66, s[44:45], 8700 glc
  s_load_dword s67, s[44:45], 12796 glc
  s_waitcnt lgkmcnt(0)
  s_xor_b32 s64, s64, s29
  s_xor_b32 s65, s65, s29
  s_xor_b32 s66, s66, s29
  s_xor_b32 s67, s67, s29
  s_or_b32 s64, s64, s65
  s_or_b32 s66, s66, s67
  s_or_b32 s64, s64, s66
  s_cmp_eq_u32 s64, 0
  s_cbranch_scc0 L_ps2e
  global_load_dwordx4 v[40:43], v14, s[12:13] sc1
  global_load_dwordx4 v[44:47], v14, s[12:13] offset:16 sc1
  s_mov_b32 s55, 1
L_ps2e:
  s_cmp_eq_u32 s55, 1
  s_cbranch_scc1 L_ps3q
  s_waitcnt vmcnt(3)
  s_cmp_lt_u32 s24, 48
  s_cselect_b32 s35, s15, 0
  s_add_u32 s36, s35, s14
  s_sub_u32 s35, s24, 48
  s_cmp_lt_u32 s35, s15
  s_cselect_b32 s35, s40, s25
  s_cselect_b32 s36, s17, s36
  s_add_u32 s34, s24, s36
  s_and_b32 s34, s34, 127
  s_lshl_b32 s34, s34, 12
  s_add_u32 s34, s34, s35
  s_mov_b32 m0, s27
  s_nop 0
  buffer_load_dwordx4 v3, s[4:7], s34 offen offset:0 nt lds
  buffer_load_dwordx4 v4, s[4:7], s34 offen offset:1024 nt lds
  buffer_load_dwordx4 v5, s[4:7], s34 offen offset:2048 nt lds
  buffer_load_dwordx4 v6, s[4:7], s34 offen offset:3072 nt lds
  s_add_u32 s24, s24, 8
  s_add_u32 s27, s27, 4096
  s_and_b32 s27, s27, 0x3fff
  s_or_b32 s27, s27, s28
L_ps3r:
  s_cmp_eq_u32 s55, 2
  s_cbranch_scc1 L_qdone
L_qpoll:
  global_load_dwordx4 v[40:43], v14, s[12:13] sc1
  global_load_dwordx4 v[44:47], v14, s[12:13] offset:16 sc1
  s_waitcnt vmcnt(0)
  v_xor_b32 v16, s29, v41
  v_bitop3_b32 v16, v16, v43, s29 bitop3:0xf6
  v_bitop3_b32 v16, v16, v45, s29 bitop3:0xf6
  v_bitop3_b32 v16, v16, v47, s29 bitop3:0xf6
  v_cmp_eq_u32 vcc, 0, v16
  s_nop 0
  s_cmp_eq_u64 vcc, -1
  s_cbranch_scc1 L_qpoll_ok
  s_sleep 1
  s_sub_u32 s31, s31, 1
  s_cmp_lg_u32 s31, 0
  s_cbranch_scc1 L_qpoll
  s_mov_b32 s31, 1
L_qpoll_ok:
  v_permlane32_swap_b32 v40, v44
  v_permlane32_swap_b32 v42, v46
  v_add_f32 v40, v40, v44
  v_add_f32 v42, v42, v46
  s_nop 1
  v_permlane16_swap_b32 v40, v42
  v_add_f32 v40, v40, v42
  v_cvt_pk_bf16_f32 v40, v40, v40
  ds_write_b16 v15, v40
L_qdone:
  s_waitcnt lgkmcnt(0)
  s_barrier
L_qops:
  v_and_b32 v14, 3, v1
  v_lshlrev_b32 v14, 8, v14
  v_lshrrev_b32 v15, 4, v1
  v_lshl_add_u32 v14, v15, 4, v14
  v_add_u32 v14, 151552, v14
  ds_read_b128 v[48:51], v14 offset:0
  ds_read_b128 v[52:55], v14 offset:64
  ds_read_b128 v[56:59], v14 offset:128
  ds_read_b128 v[60:63], v14 offset:192
  v_mov_b32 v29, 0xff800000
  v_mov_b32 v95, 1
  s_mov_b64 exec, 1
  ds_add_rtn_u32 v31, v30, v95
  s_mov_b64 exec, -1
L_notk:
  s_mov_b32 s16, s3
  s_waitcnt lgkmcnt(0)
  s_lshl_b32 s34, s16, 7
  v_add_u32 v28, s34, v10
  v_add_u32 v14, s26, v8
  v_xor_b32 v15, 64, v14
  v_xor_b32 v16, 128, v14
  v_xor_b32 v17, 192, v14
  s_waitcnt vmcnt(12)
  ds_read_b128 v[32:35], v14
  ds_read_b128 v[36:39], v15
  ds_read_b128 v[40:43], v16
  ds_read_b128 v[44:47], v17
  s_add_u32 s26, s26, 4096
  s_and_b32 s26, s26, 0x3fff
  s_or_b32 s26, s26, s28
  s_waitcnt lgkmcnt(3)
  v_mfma_f32_16x16x32_bf16 v[18:21], v[32:35], v[48:51], 0
  s_waitcnt lgkmcnt(2)
  v_mfma_f32_16x16x32_bf16 v[18:21], v[36:39], v[52:55], v[18:21]
  s_waitcnt lgkmcnt(1)
  v_mfma_f32_16x16x32_bf16 v[18:21], v[40:43], v[56:59], v[18:21]
  s_waitcnt lgkmcnt(0)
  v_mfma_f32_16x16x32_bf16 v[18:21], v[44:47], v[60:63], v[18:21]
  s_nop 7
  v_cvt_pk_bf16_f32 v22, v18, v19
  v_cvt_pk_bf16_f32 v23, v20, v21
  v_lshlrev_b32 v24, 16, v22
  v_and_b32 v25, 0xffff0000, v22
  v_lshlrev_b32 v26, 16, v23
  v_and_b32 v27, 0xffff0000, v23
  v_mul_f32 v24, 0x3db504f3, v24
  v_mul_f32 v25, 0x3db504f3, v25
  v_mul_f32 v26, 0x3db504f3, v26
  v_mul_f32 v27, 0x3db504f3, v27
  v_cvt_pk_bf16_f32 v22, v24, v25
  v_cvt_pk_bf16_f32 v23, v26, v27
  s_mov_b32 exec_lo, 0xf000f
  s_mov_b32 exec_hi, 0xf000f
  ds_write_b64 v28, v[22:23]
  s_mov_b64 exec, -1
  v_max3_f32 v29, v29, v24, v25
  v_max3_f32 v29, v29, v26, v27
  s_add_u32 s16, s16, 8
  s_lshl_b32 s34, s16, 7
  v_add_u32 v28, s34, v10
  v_add_u32 v14, s26, v8
  v_xor_b32 v15, 64, v14
  v_xor_b32 v16, 128, v14
  v_xor_b32 v17, 192, v14
  s_waitcnt vmcnt(8)
  ds_read_b128 v[32:35], v14
  ds_read_b128 v[36:39], v15
  ds_read_b128 v[40:43], v16
  ds_read_b128 v[44:47], v17
  s_add_u32 s26, s26, 4096
  s_and_b32 s26, s26, 0x3fff
  s_or_b32 s26, s26, s28
  s_waitcnt lgkmcnt(3)
  v_mfma_f32_16x16x32_bf16 v[18:21], v[32:35], v[48:51], 0
  s_waitcnt lgkmcnt(2)
  v_mfma_f32_16x16x32_bf16 v[18:21], v[36:39], v[52:55], v[18:21]
  s_waitcnt lgkmcnt(1)
  v_mfma_f32_16x16x32_bf16 v[18:21], v[40:43], v[56:59], v[18:21]
  s_waitcnt lgkmcnt(0)
  v_mfma_f32_16x16x32_bf16 v[18:21], v[44:47], v[60:63], v[18:21]
  s_nop 7
  v_cvt_pk_bf16_f32 v22, v18, v19
  v_cvt_pk_bf16_f32 v23, v20, v21
  v_lshlrev_b32 v24, 16, v22
  v_and_b32 v25, 0xffff0000, v22
  v_lshlrev_b32 v26, 16, v23
  v_and_b32 v27, 0xffff0000, v23
  v_mul_f32 v24, 0x3db504f3, v24
  v_mul_f32 v25, 0x3db504f3, v25
  v_mul_f32 v26, 0x3db504f3, v26
  v_mul_f32 v27, 0x3db504f3, v27
  v_cvt_pk_bf16_f32 v22, v24, v25
  v_cvt_pk_bf16_f32 v23, v26, v27
  s_mov_b32 exec_lo, 0xf000f
  s_mov_b32 exec_hi, 0xf000f
  ds_write_b64 v28, v[22:23]
  s_mov_b64 exec, -1
  v_max3_f32 v29, v29, v24, v25
  v_max3_f32 v29, v29, v26, v27
  s_add_u32 s16, s16, 8
  s_lshl_b32 s34, s16, 7
  v_add_u32 v28, s34, v10
  v_add_u32 v14, s26, v8
  v_xor_b32 v15, 64, v14
  v_xor_b32 v16, 128, v14
  v_xor_b32 v17, 192, v14
  s_waitcnt vmcnt(4)
  ds_read_b128 v[32:35], v14
  ds_read_b128 v[36:39], v15
  ds_read_b128 v[40:43], v16
  ds_read_b128 v[44:47], v17
  s_add_u32 s26, s26, 4096
  s_and_b32 s26, s26, 0x3fff
  s_or_b32 s26, s26, s28
  s_waitcnt lgkmcnt(3)
  v_mfma_f32_16x16x32_bf16 v[18:21], v[32:35], v[48:51], 0
  s_waitcnt lgkmcnt(2)
  v_mfma_f32_16x16x32_bf16 v[18:21], v[36:39], v[52:55], v[18:21]
  s_waitcnt lgkmcnt(1)
  v_mfma_f32_16x16x32_bf16 v[18:21], v[40:43], v[56:59], v[18:21]
  s_waitcnt lgkmcnt(0)
  v_mfma_f32_16x16x32_bf16 v[18:21], v[44:47], v[60:63], v[18:21]
  s_nop 7
  v_cvt_pk_bf16_f32 v22, v18, v19
  v_cvt_pk_bf16_f32 v23, v20, v21
  v_lshlrev_b32 v24, 16, v22
  v_and_b32 v25, 0xffff0000, v22
  v_lshlrev_b32 v26, 16, v23
  v_and_b32 v27, 0xffff0000, v23
  v_mul_f32 v24, 0x3db504f3, v24
  v_mul_f32 v25, 0x3db504f3, v25
  v_mul_f32 v26, 0x3db504f3, v26
  v_mul_f32 v27, 0x3db504f3, v27
  v_cvt_pk_bf16_f32 v22, v24, v25
  v_cvt_pk_bf16_f32 v23, v26, v27
  s_mov_b32 exec_lo, 0xf000f
  s_mov_b32 exec_hi, 0xf000f
  ds_write_b64 v28, v[22:23]
  s_mov_b64 exec, -1
  v_max3_f32 v29, v29, v24, v25
  v_max3_f32 v29, v29, v26, v27
  s_add_u32 s16, s16, 8
  s_cmp_lg_u32 s3, 3
  s_cbranch_scc1 L_nost
  s_buffer_load_dword s44, s[8:11], s25
  s_buffer_load_dword s45, s[8:11], s40
  s_buffer_load_dword s48, s[4:7], s40
  s_cmp_eq_u32 s20, 0
  s_cbranch_scc1 L_nost2
  s_load_dword s49, s[62:63], 0
  s_load_dword s50, s[60:61], 0
L_nost2:
  s_waitcnt lgkmcnt(0)
L_nost:
L_kloop:
  s_mov_b32 s36, s16
  s_lshl_b32 s34, s36, 7
  v_add_u32 v28, s34, v10
  v_add_u32 v14, s26, v8
  v_xor_b32 v15, 64, v14
  v_xor_b32 v16, 128, v14
  v_xor_b32 v17, 192, v14
  s_waitcnt lgkmcnt(0)
  v_readfirstlane_b32 s33, v31
  s_mov_b64 exec, 1
  ds_add_rtn_u32 v31, v30, v95
  s_mov_b64 exec, -1
  s_cmp_lt_u32 s33, s22
  s_cbranch_scc0 L_isV0
  s_cmp_lt_u32 s33, 48
  s_cselect_b32 s35, s15, 0
  s_add_u32 s36, s35, s14
  s_sub_u32 s35, s33, 48
  s_cmp_lt_u32 s35, s15
  s_cselect_b32 s35, s40, s25
  s_cselect_b32 s36, s17, s36
  s_add_u32 s34, s33, s36
  s_and_b32 s34, s34, 127
  s_lshl_b32 s34, s34, 12
  s_add_u32 s34, s34, s35
  s_mov_b32 m0, s27
  s_waitcnt vmcnt(0)
  buffer_load_dwordx4 v3, s[4:7], s34 offen offset:0 nt lds
  buffer_load_dwordx4 v4, s[4:7], s34 offen offset:1024 nt lds
  buffer_load_dwordx4 v5, s[4:7], s34 offen offset:2048 nt lds
  buffer_load_dwordx4 v6, s[4:7], s34 offen offset:3072 nt lds
L_isret0:
  s_add_u32 s27, s27, 4096
  s_and_b32 s27, s27, 0x3fff
  s_or_b32 s27, s27, s28
  s_mov_b32 s16, s33
  ds_read_b128 v[32:35], v14
  ds_read_b128 v[36:39], v15
  ds_read_b128 v[40:43], v16
  ds_read_b128 v[44:47], v17
  s_add_u32 s26, s26, 4096
  s_and_b32 s26, s26, 0x3fff
  s_or_b32 s26, s26, s28
  s_waitcnt lgkmcnt(3)
  v_mfma_f32_16x16x32_bf16 v[18:21], v[32:35], v[48:51], 0
  s_waitcnt lgkmcnt(2)
  v_mfma_f32_16x16x32_bf16 v[18:21], v[36:39], v[52:55], v[18:21]
  s_waitcnt lgkmcnt(1)
  v_mfma_f32_16x16x32_bf16 v[18:21], v[40:43], v[56:59], v[18:21]
  s_waitcnt lgkmcnt(0)
  v_mfma_f32_16x16x32_bf16 v[18:21], v[44:47], v[60:63], v[18:21]
  s_nop 7
  v_cvt_pk_bf16_f32 v22, v18, v19
  v_cvt_pk_bf16_f32 v23, v20, v21
  v_lshlrev_b32 v24, 16, v22
  v_and_b32 v25, 0xffff0000, v22
  v_lshlrev_b32 v26, 16, v23
  v_and_b32 v27, 0xffff0000, v23
  v_mul_f32 v24, 0x3db504f3, v24
  v_mul_f32 v25, 0x3db504f3, v25
  v_mul_f32 v26, 0x3db504f3, v26
  v_mul_f32 v27, 0x3db504f3, v27
  v_cvt_pk_bf16_f32 v22, v24, v25
  v_cvt_pk_bf16_f32 v23, v26, v27
  s_mov_b32 exec_lo, 0xf000f
  s_mov_b32 exec_hi, 0xf000f
  ds_write_b64 v28, v[22:23]
  s_mov_b64 exec, -1
  v_max3_f32 v29, v29, v24, v25
  v_max3_f32 v29, v29, v26, v27
  s_cmp_lt_u32 s16, s22
  s_cbranch_scc1 L_kloop
L_kdone:
  v_mov_b32 v16, v29
  s_nop 1
  v_permlane16_swap_b32 v29, v16
  v_max_f32 v29, v29, v16
  v_mov_b32 v16, v29
  s_nop 1
  v_permlane32_swap_b32 v29, v16
  v_max_f32 v29, v29, v16
  v_cvt_pk_bf16_f32 v29, v29, v29
  v_and_b32 v29, 0xffff0000, v29
  s_lshl_b32 s34, s3, 2
  s_add_u32 s34, s34, 152576
  v_and_b32 v17, 3, v1
  v_lshlrev_b32 v17, 5, v17
  v_add_u32 v16, s34, v17
  v_add_u32 v17, 152576, v17
  s_mov_b64 exec, 0xf
  ds_write_b32 v16, v29
  s_mov_b64 exec, -1
  s_waitcnt lgkmcnt(0)
  s_barrier
  ds_read_b128 v[80:83], v17
  ds_read_b128 v[84:87], v17 offset:16
  ds_read_b64 v[32:33], v11 offset:0
  ds_read_b64 v[34:35], v11 offset:512
  ds_read_b64 v[36:37], v11 offset:1024
  ds_read_b64 v[38:39], v11 offset:1536
  ds_read_b64 v[40:41], v11 offset:2048
  s_waitcnt lgkmcnt(5)
  v_max3_f32 v14, v80, v81, v82
  v_max3_f32 v83, v83, v84, v85
  v_max3_f32 v14, v14, v86, v87
  v_max_f32 v14, v14, v83
  s_mov_b32 s34, 0x3fb8aa3b
  v_mul_f32 v18, s34, v14
  s_waitcnt lgkmcnt(4)
  v_lshlrev_b32 v48, 16, v32
  v_and_b32 v49, 0xffff0000, v32
  v_lshlrev_b32 v50, 16, v33
  v_and_b32 v51, 0xffff0000, v33
  s_waitcnt lgkmcnt(3)
  v_lshlrev_b32 v52, 16, v34
  v_and_b32 v53, 0xffff0000, v34
  v_lshlrev_b32 v54, 16, v35
  v_and_b32 v55, 0xffff0000, v35
  s_waitcnt lgkmcnt(2)
  v_lshlrev_b32 v56, 16, v36
  v_and_b32 v57, 0xffff0000, v36
  v_lshlrev_b32 v58, 16, v37
  v_and_b32 v59, 0xffff0000, v37
  s_waitcnt lgkmcnt(1)
  v_lshlrev_b32 v60, 16, v38
  v_and_b32 v61, 0xffff0000, v38
  v_lshlrev_b32 v62, 16, v39
  v_and_b32 v63, 0xffff0000, v39
  s_waitcnt lgkmcnt(0)
  v_lshlrev_b32 v64, 16, v40
  v_and_b32 v65, 0xffff0000, v40
  v_lshlrev_b32 v66, 16, v41
  v_and_b32 v67, 0xffff0000, v41
  v_fma_f32 v48, v48, s34, -v18
  v_fma_f32 v49, v49, s34, -v18
  v_fma_f32 v50, v50, s34, -v18
  v_fma_f32 v51, v51, s34, -v18
  v_fma_f32 v52, v52, s34, -v18
  v_fma_f32 v53, v53, s34, -v18
  v_fma_f32 v54, v54, s34, -v18
  v_fma_f32 v55, v55, s34, -v18
  v_fma_f32 v56, v56, s34, -v18
  v_fma_f32 v57, v57, s34, -v18
  v_fma_f32 v58, v58, s34, -v18
  v_fma_f32 v59, v59, s34, -v18
  v_fma_f32 v60, v60, s34, -v18
  v_fma_f32 v61, v61, s34, -v18
  v_fma_f32 v62, v62, s34, -v18
  v_fma_f32 v63, v63, s34, -v18
  v_fma_f32 v64, v64, s34, -v18
  v_fma_f32 v65, v65, s34, -v18
  v_fma_f32 v66, v66, s34, -v18
  v_fma_f32 v67, v67, s34, -v18
  v_exp_f32 v48, v48
  v_exp_f32 v49, v49
  v_exp_f32 v50, v50
  v_exp_f32 v51, v51
  v_exp_f32 v52, v52
  v_exp_f32 v53, v53
  v_exp_f32 v54, v54
  v_exp_f32 v55, v55
  v_exp_f32 v56, v56
  v_exp_f32 v57, v57
  v_exp_f32 v58, v58
  v_exp_f32 v59, v59
  v_exp_f32 v60, v60
  v_exp_f32 v61, v61
  v_exp_f32 v62, v62
  v_exp_f32 v63, v63
  v_exp_f32 v64, v64
  v_exp_f32 v65, v65
  v_exp_f32 v66, v66
  v_exp_f32 v67, v67
  v_cvt_pk_bf16_f32 v32, v48, v49
  v_cvt_pk_bf16_f32 v33, v50, v51
  v_cvt_pk_bf16_f32 v34, v52, v53
  v_cvt_pk_bf16_f32 v35, v54, v55
  v_cvt_pk_bf16_f32 v36, v56, v57
  v_cvt_pk_bf16_f32 v37, v58, v59
  v_cvt_pk_bf16_f32 v38, v60, v61
  v_cvt_pk_bf16_f32 v39, v62, v63
  v_cvt_pk_bf16_f32 v40, v64, v65
  v_cvt_pk_bf16_f32 v41, v66, v67
  ds_write_b64 v11, v[32:33] offset:0
  ds_write_b64 v11, v[34:35] offset:512
  ds_write_b64 v11, v[36:37] offset:1024
  ds_write_b64 v11, v[38:39] offset:1536
  ds_write_b64 v11, v[40:41] offset:2048
  v_add_f32 v48, v48, v58
  v_add_f32 v49, v49, v59
  v_add_f32 v50, v50, v60
  v_add_f32 v51, v51, v61
  v_add_f32 v52, v52, v62
  v_add_f32 v53, v53, v63
  v_add_f32 v54, v54, v64
  v_add_f32 v55, v55, v65
  v_add_f32 v56, v56, v66
  v_add_f32 v57, v57, v67
  v_add_f32 v48, v48, v53
  v_add_f32 v49, v49, v54
  v_add_f32 v50, v50, v55
  v_add_f32 v51, v51, v56
  v_add_f32 v52, v52, v57
  v_add_f32 v48, v48, v49
  v_add_f32 v50, v50, v51
  v_add_f32 v48, v48, v52
  v_add_f32 v15, v48, v50
  s_nop 1
  v_add_f32_dpp v15, v15, v15 row_ror:4 row_mask:0xf bank_mask:0xf
  s_nop 1
  v_add_f32_dpp v15, v15, v15 row_ror:8 row_mask:0xf bank_mask:0xf
  v_mov_b32 v19, v15
  s_nop 1
  v_permlane16_swap_b32 v15, v19
  v_add_f32 v15, v15, v19
  v_mov_b32 v19, v15
  s_nop 1
  v_permlane32_swap_b32 v15, v19
  v_add_f32 v15, v15, v19
  s_mov_b64 exec, 0xf
  ds_write_b32 v16, v15 offset:128
  s_mov_b64 exec, -1
  v_mov_b32 v29, v14
  v_and_b32 v24, 3, v1
  s_movk_i32 s34, 576
  v_mul_lo_u32 v24, v24, s34
  v_lshrrev_b32 v25, 4, v1
  v_lshl_add_u32 v24, v25, 4, v24
  v_add_u32 v24, s28, v24
  s_lshr_b32 s34, s3, 1
  s_and_b32 s35, s3, 1
  s_lshl_b32 s35, s35, 8
  s_mul_i32 s36, s34, 576
  s_add_u32 s36, s36, s35
  v_lshl_add_u32 v25, v1, 2, s36
  v_add_u32 v26, 0x10000, v25
  s_lshl_b32 s36, s34, 4
  s_add_u32 s36, s36, 152840
  v_mov_b32 v27, s36
  s_lshl_b32 s36, s18, 2
  s_add_u32 s36, s36, s34
  s_lshl_b32 s36, s36, 13
  s_lshr_b32 s35, s35, 1
  s_add_u32 s36, s36, s35
  s_lshl_b32 s34, s19, 8
  s_add_u32 s36, s36, s34
  s_add_u32 s36, s36, 131072
  v_lshl_add_u32 v28, v1, 1, s36
  s_waitcnt lgkmcnt(0)
  s_barrier
  s_cmp_lg_u32 s3, 0
  s_cbranch_scc1 L_noml
  ds_read_b128 v[80:83], v17 offset:128
  ds_read_b128 v[84:87], v17 offset:144
  s_lshl_b32 s34, s18, 11
  s_lshl_b32 s35, s19, 6
  s_add_u32 s34, s34, s35
  s_add_u32 s34, s34, 32768
  v_add_u32 v16, s34, v2
  v_mov_b32 v20, v29
  v_mov_b32 v21, s29
  v_mov_b32 v23, s29
  s_waitcnt lgkmcnt(0)
  v_pk_add_f32 v[80:81], v[80:81], v[82:83]
  v_pk_add_f32 v[84:85], v[84:85], v[86:87]
  v_pk_add_f32 v[80:81], v[80:81], v[84:85]
  v_add_f32 v80, v80, v81
  v_mov_b32 v22, v80
  s_mov_b64 exec, 0xf
  global_store_dwordx4 v16, v[20:23], s[12:13] sc1
  s_mov_b64 exec, -1
L_noml:
  s_cmp_eq_u32 s20, 1
  s_cbranch_scc1 L_wB
L_wBret:
  v_mov_b32 v48, 0
  v_mov_b32 v49, 0
  v_mov_b32 v50, 0
  v_mov_b32 v51, 0
  v_mov_b32 v52, 0
  v_mov_b32 v53, 0
  v_mov_b32 v54, 0
  v_mov_b32 v55, 0
  v_mov_b32 v56, 0
  v_mov_b32 v57, 0
  v_mov_b32 v58, 0
  v_mov_b32 v59, 0
  v_mov_b32 v60, 0
  v_mov_b32 v61, 0
  v_mov_b32 v62, 0
  v_mov_b32 v63, 0
  v_mov_b32 v64, 0
  v_mov_b32 v65, 0
  v_mov_b32 v66, 0
  v_mov_b32 v67, 0
  v_mov_b32 v68, 0
  v_mov_b32 v69, 0
  v_mov_b32 v70, 0
  v_mov_b32 v71, 0
  v_mov_b32 v72, 0
  v_mov_b32 v73, 0
  v_mov_b32 v74, 0
  v_mov_b32 v75, 0
  v_mov_b32 v76, 0
  v_mov_b32 v77, 0
  v_mov_b32 v78, 0
  v_mov_b32 v79, 0
  s_lshl_b32 s34, s22, 7
  v_subrev_u32 v10, s34, v10
  s_branch L_vtest
L_vloop:
  s_lshl_b32 s34, s16, 7
  v_add_u32 v15, s34, v10
  v_add_u32 v14, s26, v9
  ds_read_b64 v[16:17], v15
  s_waitcnt lgkmcnt(0)
  v_readfirstlane_b32 s33, v31
  s_mov_b64 exec, 1
  ds_add_rtn_u32 v31, v30, v95
  s_mov_b64 exec, -1
  s_sub_u32 s34, s33, s22
  s_cmp_lt_u32 s34, 48
  s_cselect_b32 s35, s15, 0
  s_add_u32 s36, s35, s14
  s_sub_u32 s35, s34, 48
  s_cmp_lt_u32 s35, s15
  s_cselect_b32 s35, s40, s25
  s_cselect_b32 s36, s17, s36
  s_add_u32 s34, s34, s36
  s_and_b32 s34, s34, 127
  s_lshl_b32 s34, s34, 12
  s_add_u32 s34, s34, s35
  s_mov_b32 m0, s27
  s_cmp_lt_u32 s33, s23
  s_waitcnt vmcnt(0)
  s_cbranch_scc0 L_isno1
  buffer_load_dwordx4 v7, s[8:11], s34 offen offset:0 nt lds
  buffer_load_dwordx4 v7, s[8:11], s34 offen offset:1024 nt lds
  buffer_load_dwordx4 v7, s[8:11], s34 offen offset:2048 nt lds
  buffer_load_dwordx4 v7, s[8:11], s34 offen offset:3072 nt lds
L_isno1:
  s_add_u32 s27, s27, 4096
  s_and_b32 s27, s27, 0x3fff
  s_or_b32 s27, s27, s28
  s_mov_b32 s16, s33
  ds_read_b64_tr_b16 v[32:33], v14 offset:0
  ds_read_b64_tr_b16 v[34:35], v14 offset:128
  ds_read_b64_tr_b16 v[36:37], v14 offset:256
  ds_read_b64_tr_b16 v[38:39], v14 offset:384
  ds_read_b64_tr_b16 v[40:41], v14 offset:512
  ds_read_b64_tr_b16 v[42:43], v14 offset:640
  ds_read_b64_tr_b16 v[44:45], v14 offset:768
  ds_read_b64_tr_b16 v[46:47], v14 offset:896
  s_add_u32 s26, s26, 4096
  s_and_b32 s26, s26, 0x3fff
  s_or_b32 s26, s26, s28
  s_waitcnt lgkmcnt(7)
  v_mfma_f32_16x16x16_bf16 v[48:51], v[32:33], v[16:17], v[48:51]
  s_waitcnt lgkmcnt(6)
  v_mfma_f32_16x16x16_bf16 v[52:55], v[34:35], v[16:17], v[52:55]
  s_waitcnt lgkmcnt(5)
  v_mfma_f32_16x16x16_bf16 v[56:59], v[36:37], v[16:17], v[56:59]
  s_waitcnt lgkmcnt(4)
  v_mfma_f32_16x16x16_bf16 v[60:63], v[38:39], v[16:17], v[60:63]
  s_waitcnt lgkmcnt(3)
  v_mfma_f32_16x16x16_bf16 v[64:67], v[40:41], v[16:17], v[64:67]
  s_waitcnt lgkmcnt(2)
  v_mfma_f32_16x16x16_bf16 v[68:71], v[42:43], v[16:17], v[68:71]
  s_waitcnt lgkmcnt(1)
  v_mfma_f32_16x16x16_bf16 v[72:75], v[44:45], v[16:17], v[72:75]
  s_waitcnt lgkmcnt(0)
  v_mfma_f32_16x16x16_bf16 v[76:79], v[46:47], v[16:17], v[76:79]
L_vtest:
  s_cmp_ge_u32 s16, s42
  s_cbranch_scc1 L_gather
L_gatherret:
  s_cmp_lt_u32 s16, s23
  s_cbranch_scc1 L_vloop
  s_mov_b32 exec_lo, 0xf000f
  s_mov_b32 exec_hi, 0xf000f
  ds_write_b128 v24, v[48:51] offset:0
  ds_write_b128 v24, v[52:55] offset:64
  ds_write_b128 v24, v[56:59] offset:128
  ds_write_b128 v24, v[60:63] offset:192
  ds_write_b128 v24, v[64:67] offset:256
  ds_write_b128 v24, v[68:71] offset:320
  ds_write_b128 v24, v[72:75] offset:384
  ds_write_b128 v24, v[76:79] offset:448
  s_mov_b64 exec, -1
  s_waitcnt lgkmcnt(0)
  s_barrier
  ds_read2st64_b32 v[32:33], v25 offset0:0 offset1:64
  ds_read2st64_b32 v[34:35], v25 offset0:128 offset1:192
  ds_read2st64_b32 v[36:37], v26 offset0:0 offset1:64
  ds_read2st64_b32 v[38:39], v26 offset0:128 offset1:192
  ds_read_b64 v[40:41], v27
  s_waitcnt lgkmcnt(0)
  v_readfirstlane_b32 s41, v41
  v_pk_add_f32 v[32:33], v[32:33], v[34:35]
  v_pk_add_f32 v[36:37], v[36:37], v[38:39]
  v_pk_add_f32 v[32:33], v[32:33], v[36:37]
  v_add_f32 v32, v32, v33
  v_mul_f32 v32, v32, v40
  s_nop 1
  v_mov_b32_dpp v33, v32 quad_perm:[1,1,3,3] row_mask:0xf bank_mask:0xf
  v_cvt_pk_bf16_f32 v36, v32, v33
  v_min_u32 v36, -2, v36
  s_nop 1
  v_mov_b32_dpp v37, v36 row_shl:2 row_mask:0xf bank_mask:0xf
  v_mov_b32_dpp v38, v36 row_shl:4 row_mask:0xf bank_mask:0xf
  v_mov_b32_dpp v39, v36 row_shl:6 row_mask:0xf bank_mask:0xf
  s_mov_b32 exec_lo, 0x1010101
  s_mov_b32 exec_hi, 0x1010101
  s_cmp_eq_u32 s41, 1
  s_cbranch_scc1 L_p1f
  global_store_dwordx4 v28, v[36:39], s[12:13] sc1
L_p1r:
  s_mov_b64 exec, -1
  s_cmp_eq_u32 s20, 0
  s_cbranch_scc1 L_end
  v_lshrrev_b32 v22, 1, v1
  v_and_b32 v23, 1, v1
  s_lshl_b32 s34, s21, 13
  s_lshl_b32 s35, s3, 5
  s_add_u32 s34, s34, s35
  s_add_u32 s34, s34, 131072
  v_lshl_add_u32 v14, v22, 8, s34
  v_lshl_add_u32 v14, v23, 4, v14
  s_lshl_b32 s34, s21, 11
  s_add_u32 s34, s34, 655360
  v_lshl_add_u32 v15, v1, 5, s34
  v_lshlrev_b32 v16, 5, v1
  v_add_u32 v16, 53248, v16
  v_lshrrev_b32 v17, 5, v1
  v_bfe_u32 v24, v1, 4, 1
  v_lshl_add_u32 v17, v17, 1, v24
  v_lshl_add_u32 v17, v23, 2, v17
  s_lshl_b32 s34, s3, 5
  s_add_u32 s34, s34, 153088
  v_lshl_add_u32 v17, v17, 2, s34
  v_lshrrev_b32 v18, 4, v1
  v_lshlrev_b32 v18, 5, v18
  v_lshl_add_u32 v18, v23, 4, v18
  v_add_u32 v18, 151552, v18
  s_mov_b32 s34, 0xaaaaaaaa
  v_mul_lo_u32 v19, v23, s34
  v_add_u32 v19, 0x44444444, v19
  global_load_dwordx4 v[52:55], v15, s[12:13] sc1
  global_load_dwordx4 v[56:59], v16, s[12:13] sc1
  v_add_u32 v24, 65536, v15
  global_load_dwordx4 v[60:63], v24, s[12:13] sc1
  s_lshl_b32 s34, s21, 6
  s_lshl_b32 s35, s3, 13
  s_add_u32 s34, s34, s35
  s_add_u32 s34, s34, 655360
  v_lshrrev_b32 v20, 4, v1
  v_lshl_add_u32 v20, v20, 11, s34
  v_and_b32 v24, 15, v1
  v_lshl_add_u32 v20, v24, 2, v20
  v_lshrrev_b32 v24, 5, v1
  v_lshlrev_b32 v21, 3, v23
  v_lshl_add_u32 v21, v24, 2, v21
  v_bfe_u32 v24, v1, 4, 1
  v_lshl_add_u32 v21, v24, 1, v21
  v_bfe_u32 v24, v1, 3, 1
  v_add_u32 v21, v24, v21
  s_lshl_b32 s34, s21, 4
  v_add_u32 v21, s34, v21
  v_lshlrev_b32 v31, 1, v21
  global_load_ushort v48, v31, s[62:63]
  v_lshlrev_b32 v21, 2, v21
  v_add_u32 v21, 53248, v21
  s_lshl_b32 s34, s3, 4
  s_add_u32 s34, s34, 153344
  v_lshl_add_u32 v25, v1, 1, s34
  s_and_b32 s55, s29, 0xffff
  v_mov_b32 v30, s55
  s_mov_b32 s54, 0xffff
  s_mov_b64 s[44:45], 0xffff
  s_lshl_b64 s[46:47], s[44:45], 16
  s_lshl_b64 s[48:49], s[44:45], 32
  s_lshl_b64 s[50:51], s[44:45], 48
  v_mov_b32 v80, 0
  v_mov_b32 v81, 0
  v_mov_b32 v82, 0
  v_mov_b32 v83, 0
  v_mov_b32 v84, 0
  v_mov_b32 v85, 0
  v_mov_b32 v86, 0
  v_mov_b32 v87, 0
  v_mov_b32 v88, 0
  v_mov_b32 v89, 0
  v_mov_b32 v90, 0
  v_mov_b32 v91, 0
  v_mov_b32 v92, 0
  v_mov_b32 v93, 0
  v_mov_b32 v94, 0
  v_mov_b32 v95, 0
  v_mov_b32 v40, 0
  v_mov_b32 v41, 0
  v_mov_b32 v42, 0
  v_mov_b32 v43, 0
  v_mov_b32 v44, 0
  v_mov_b32 v45, 0
  v_mov_b32 v46, 0
  v_mov_b32 v47, 0
  v_add_u32 v29, 151552, v2
  v_mov_b32 v64, v13
  v_mov_b32 v65, v13
  v_mov_b32 v66, v13
  v_mov_b32 v67, v13
  v_mov_b32 v68, v13
  v_mov_b32 v69, v13
  v_mov_b32 v70, v13
  v_mov_b32 v71, v13
  v_mov_b32 v72, v13
  v_mov_b32 v73, v13
  v_mov_b32 v74, v13
  v_mov_b32 v75, v13
  v_mov_b32 v76, v13
  v_mov_b32 v77, v13
  v_mov_b32 v78, v13
  v_mov_b32 v79, v13
  global_load_dwordx4 v[48:51], v14, s[12:13] sc1
L_h1:
  s_waitcnt vmcnt(0)
  v_max3_u32 v22, v48, v49, v50
  v_max_u32 v22, v22, v51
  v_cmp_eq_u32 vcc, -1, v22
  s_nop 0
  s_and_b64 exec, exec, vcc
  s_cbranch_execz L_h1_ok
  s_sleep 1
  global_load_dwordx4 v[48:51], v14, s[12:13] sc1
  s_sub_u32 s31, s31, 1
  s_cmp_lg_u32 s31, 0
  s_cbranch_scc1 L_h1
  s_mov_b32 s31, 1
  s_waitcnt vmcnt(0)
L_h1_ok:
  s_mov_b64 exec, -1
  v_lshlrev_b32 v32, 16, v48
  v_and_b32 v33, 0xffff0000, v48
  v_lshlrev_b32 v34, 16, v49
  v_and_b32 v35, 0xffff0000, v49
  v_lshlrev_b32 v36, 16, v50
  v_and_b32 v37, 0xffff0000, v50
  v_lshlrev_b32 v38, 16, v51
  v_and_b32 v39, 0xffff0000, v51
  v_permlane32_swap_b32 v32, v36
  v_permlane32_swap_b32 v33, v37
  v_permlane32_swap_b32 v34, v38
  v_permlane32_swap_b32 v35, v39
  v_add_f32 v32, v32, v36
  v_add_f32 v33, v33, v37
  v_add_f32 v34, v34, v38
  v_add_f32 v35, v35, v39
  s_nop 0
  v_permlane16_swap_b32 v32, v34
  v_permlane16_swap_b32 v33, v35
  v_add_f32 v32, v32, v34
  v_add_f32 v33, v33, v35
  s_nop 0
  v_add_f32_dpp v32, v32, v32 row_ror:8 row_mask:0xf bank_mask:0xf
  v_add_f32_dpp v33, v33, v33 row_ror:8 row_mask:0xf bank_mask:0xf
  s_nop 0
  v_add_f32_dpp v32, v32, v32 row_shl:4 row_mask:0xf bank_mask:0xf
  v_add_f32_dpp v33, v33, v33 row_shl:4 row_mask:0xf bank_mask:0xf
  s_nop 0
  v_add_f32_dpp v32, v32, v32 quad_perm:[2,3,0,1] row_mask:0xf bank_mask:0xf
  v_add_f32_dpp v33, v33, v33 quad_perm:[2,3,0,1] row_mask:0xf bank_mask:0xf
  v_cvt_pk_bf16_f32 v32, v32, v33
  s_mov_b32 exec_lo, 0x30003
  s_mov_b32 exec_hi, 0x30003
  ds_write_b32 v17, v32
  s_mov_b64 exec, -1
  s_waitcnt lgkmcnt(0)
  s_barrier
  ds_read_b128 v[32:35], v18 offset:1536
  ds_read_b128 v[36:39], v18 offset:1664
  s_waitcnt lgkmcnt(1)
  v_smfmac_f32_16x16x64_bf16 v[80:83], v[32:35], v[96:103], v19
  v_smfmac_f32_16x16x64_bf16 v[84:87], v[32:35], v[112:119], v19
  v_smfmac_f32_16x16x64_bf16 v[88:91], v[32:35], v[128:135], v19
  v_smfmac_f32_16x16x64_bf16 v[92:95], v[32:35], v[144:151], v19
  s_waitcnt lgkmcnt(0)
  v_smfmac_f32_16x16x64_bf16 v[80:83], v[36:39], v[104:111], v19
  v_smfmac_f32_16x16x64_bf16 v[84:87], v[36:39], v[120:127], v19
  v_smfmac_f32_16x16x64_bf16 v[88:91], v[36:39], v[136:143], v19
  v_smfmac_f32_16x16x64_bf16 v[92:95], v[36:39], v[152:159], v19
  s_mov_b64 exec, s[44:45]
  s_nop 3
  v_add_f32 v32, v80, v81
  s_mov_b64 exec, s[46:47]
  v_add_f32 v32, v84, v85
  s_mov_b64 exec, s[48:49]
  v_add_f32 v32, v88, v89
  s_mov_b64 exec, s[50:51]
  v_add_f32 v32, v92, v93
  s_mov_b64 exec, -1
  v_bfi_b32 v32, s39, v13, v32
  s_cmp_eq_u32 s41, 1
  s_cbranch_scc0 L_slow0
  global_store_dword v20, v32, s[12:13]
L_slowret0:
  s_cmp_lg_u32 s3, 0
  s_cbranch_scc1 L_h3w
  global_load_dwordx4 v[48:51], v15, s[12:13] sc1
  global_load_dwordx4 v[52:55], v15, s[12:13] offset:16 sc1
  v_mov_b32 v80, 0
  v_mov_b32 v81, 0
  v_mov_b32 v82, 0
  v_mov_b32 v83, 0
  v_mov_b32 v84, 0
  v_mov_b32 v85, 0
  v_mov_b32 v86, 0
  v_mov_b32 v87, 0
  v_mov_b32 v88, 0
  v_mov_b32 v89, 0
  v_mov_b32 v90, 0
  v_mov_b32 v91, 0
  v_mov_b32 v92, 0
  v_mov_b32 v93, 0
  v_mov_b32 v94, 0
  v_mov_b32 v95, 0
  v_add_u32 v20, 65536, v20
L_hA:
  s_waitcnt vmcnt(0)
  v_xor_b32 v32, s30, v48
  v_xor_b32 v33, s30, v49
  v_xor_b32 v34, s30, v50
  v_xor_b32 v35, s30, v51
  v_xor_b32 v36, s30, v52
  v_xor_b32 v37, s30, v53
  v_xor_b32 v38, s30, v54
  v_xor_b32 v39, s30, v55
  v_or3_b32 v22, v32, v33, v34
  v_or3_b32 v23, v35, v36, v37
  v_or3_b32 v22, v22, v38, v39
  v_bitop3_b32 v22, v22, v23, s39 bitop3:0xa8
  v_cmp_eq_u32 vcc, 0, v22
  s_nop 0
  s_cmp_eq_u64 vcc, -1
  s_cbranch_scc1 L_hA_ok
  global_load_dwordx4 v[48:51], v15, s[12:13] sc1
  global_load_dwordx4 v[52:55], v15, s[12:13] offset:16 sc1
  s_sub_u32 s31, s31, 1
  s_cmp_lg_u32 s31, 0
  s_cbranch_scc1 L_hA
  s_mov_b32 s31, 1
L_hA_ok:
  v_permlane32_swap_b32 v32, v36
  v_permlane32_swap_b32 v33, v37
  v_permlane32_swap_b32 v34, v38
  v_permlane32_swap_b32 v35, v39
  v_add_f32 v32, v32, v36
  v_add_f32 v33, v33, v37
  v_add_f32 v34, v34, v38
  v_add_f32 v35, v35, v39
  s_nop 0
  v_permlane16_swap_b32 v32, v34
  v_permlane16_swap_b32 v33, v35
  v_add_f32 v32, v32, v34
  v_add_f32 v33, v33, v35
  s_nop 0
  v_add_f32_dpp v34, v32, v32 row_ror:8 row_mask:0xf bank_mask:0x3
  s_nop 1
  v_add_f32_dpp v34, v33, v33 row_ror:8 row_mask:0xf bank_mask:0xc
  s_nop 1
  v_add_f32_dpp v32, v34, v34 row_shl:4 row_mask:0xf bank_mask:0xf
  s_nop 1
  v_add_f32_dpp v33, v32, v32 quad_perm:[2,3,0,1] row_mask:0xf bank_mask:0xf
  v_cvt_pk_bf16_f32 v33, v33, v33
  v_and_b32 v33, 0xffff0000, v33
  v_add_f32 v12, v12, v33
  v_cvt_pk_bf16_f32 v12, v12, v12
  v_bfi_b32 v34, s54, v30, v12
  s_mov_b32 exec_lo, 0x3030303
  s_mov_b32 exec_hi, 0x3030303
  s_cmp_eq_u32 s41, 1
  s_cbranch_scc0 L_slow1
  global_store_dword v21, v34, s[12:13]
L_slowret1:
  s_mov_b64 exec, -1
  v_and_b32 v12, 0xffff0000, v12
L_h3:
  s_cmp_ge_u32 s21, 28
  s_cbranch_scc1 L_hB0
  global_load_dwordx4 v[48:51], v16, s[12:13] sc1
  global_load_dwordx4 v[52:55], v16, s[12:13] offset:16 sc1
L_h3p:
  s_waitcnt vmcnt(0)
  v_xor_b32 v32, s55, v48
  v_xor_b32 v33, s55, v49
  v_xor_b32 v34, s55, v50
  v_xor_b32 v35, s55, v51
  v_xor_b32 v36, s55, v52
  v_xor_b32 v37, s55, v53
  v_xor_b32 v38, s55, v54
  v_xor_b32 v39, s55, v55
  v_or3_b32 v22, v32, v33, v34
  v_or3_b32 v23, v35, v36, v37
  v_or3_b32 v22, v22, v38, v39
  v_bitop3_b32 v22, v22, v23, s54 bitop3:0xa8
  v_cmp_eq_u32 vcc, 0, v22
  s_nop 0
  s_cmp_eq_u64 vcc, -1
  s_cbranch_scc1 L_h3p_ok
  global_load_dwordx4 v[48:51], v16, s[12:13] sc1
  global_load_dwordx4 v[52:55], v16, s[12:13] offset:16 sc1
  s_sub_u32 s31, s31, 1
  s_cmp_lg_u32 s31, 0
  s_cbranch_scc1 L_h3p
  s_mov_b32 s31, 1
L_h3p_ok:
  v_readfirstlane_b32 s36, v32
  v_mov_b32 v24, 0x3b000000
  s_mov_b32 s32, s36
  s_mov_b32 s33, s36
  v_pk_add_f32 v[128:129], v[32:33], s[32:33] neg_lo:[0,1] neg_hi:[0,1]
  v_pk_add_f32 v[130:131], v[34:35], s[32:33] neg_lo:[0,1] neg_hi:[0,1]
  v_pk_add_f32 v[132:133], v[36:37], s[32:33] neg_lo:[0,1] neg_hi:[0,1]
  v_pk_add_f32 v[134:135], v[38:39], s[32:33] neg_lo:[0,1] neg_hi:[0,1]
  v_pk_mul_f32 v[60:61], v[128:129], v[128:129]
  v_pk_add_f32 v[62:63], v[128:129], v[130:131]
  v_pk_fma_f32 v[60:61], v[130:131], v[130:131], v[60:61]
  v_pk_fma_f32 v[60:61], v[132:133], v[132:133], v[60:61]
  v_pk_fma_f32 v[60:61], v[134:135], v[134:135], v[60:61]
  v_pk_add_f32 v[132:133], v[132:133], v[134:135]
  v_pk_add_f32 v[62:63], v[62:63], v[132:133]
  v_add_f32 v23, v60, v61
  v_add_f32 v22, v62, v63
  s_nop 0
  v_add_f32_dpp v23, v23, v23 quad_perm:[1,0,3,2] row_mask:0xf bank_mask:0xf
  v_add_f32_dpp v22, v22, v22 quad_perm:[1,0,3,2] row_mask:0xf bank_mask:0xf
  s_nop 0
  v_add_f32_dpp v23, v23, v23 quad_perm:[2,3,0,1] row_mask:0xf bank_mask:0xf
  v_add_f32_dpp v22, v22, v22 quad_perm:[2,3,0,1] row_mask:0xf bank_mask:0xf
  s_nop 0
  v_add_f32_dpp v23, v23, v23 row_half_mirror row_mask:0xf bank_mask:0xf
  v_add_f32_dpp v22, v22, v22 row_half_mirror row_mask:0xf bank_mask:0xf
  s_nop 0
  v_add_f32_dpp v23, v23, v23 row_mirror row_mask:0xf bank_mask:0xf
  v_add_f32_dpp v22, v22, v22 row_mirror row_mask:0xf bank_mask:0xf
  s_nop 0
  v_add_f32_dpp v23, v23, v23 row_bcast:15 row_mask:0xa bank_mask:0xf
  v_add_f32_dpp v22, v22, v22 row_bcast:15 row_mask:0xa bank_mask:0xf
  s_nop 0
  v_add_f32_dpp v23, v23, v23 row_bcast:31 row_mask:0xc bank_mask:0xf
  v_add_f32_dpp v22, v22, v22 row_bcast:31 row_mask:0xc bank_mask:0xf
  v_readlane_b32 s33, v23, 63
  v_readlane_b32 s32, v22, 63
  s_nop 0
  v_mul_f32 v23, s33, v24
  v_mul_f32 v22, s32, v24
  v_fma_f32 v23, -v22, v22, v23
  v_add_f32 v22, s36, v22
  v_max_f32 v23, 0, v23
  v_cvt_pk_bf16_f32 v24, v22, v23
  v_and_b32 v23, 0xffff0000, v24
  v_lshlrev_b32 v60, 16, v24
  v_add_f32 v23, 0x3727c5ac, v23
  v_lshlrev_b32 v61, 16, v24
  v_cvt_pk_bf16_f32 v23, v23, v23
  v_pk_add_f32 v[32:33], v[32:33], v[60:61] neg_lo:[0,1] neg_hi:[0,1]
  v_and_b32 v23, 0xffff0000, v23
  v_sqrt_f32 v23, v23
  v_pk_add_f32 v[34:35], v[34:35], v[60:61] neg_lo:[0,1] neg_hi:[0,1]
  v_pk_add_f32 v[36:37], v[36:37], v[60:61] neg_lo:[0,1] neg_hi:[0,1]
  v_pk_add_f32 v[38:39], v[38:39], v[60:61] neg_lo:[0,1] neg_hi:[0,1]
  v_cvt_pk_bf16_f32 v23, v23, v23
  v_cvt_pk_bf16_f32 v56, v32, v33
  v_and_b32 v23, 0xffff0000, v23
  v_rcp_f32 v62, v23
  v_cvt_pk_bf16_f32 v57, v34, v35
  v_cvt_pk_bf16_f32 v58, v36, v37
  v_cvt_pk_bf16_f32 v59, v38, v39
  v_mov_b32 v63, v62
  v_lshlrev_b32 v32, 16, v56
  v_and_b32 v33, 0xffff0000, v56
  v_lshlrev_b32 v34, 16, v57
  v_and_b32 v35, 0xffff0000, v57
  v_lshlrev_b32 v36, 16, v58
  v_and_b32 v37, 0xffff0000, v58
  v_lshlrev_b32 v38, 16, v59
  v_and_b32 v39, 0xffff0000, v59
  v_pk_mul_f32 v[32:33], v[32:33], v[62:63]
  v_pk_mul_f32 v[34:35], v[34:35], v[62:63]
  v_pk_mul_f32 v[36:37], v[36:37], v[62:63]
  v_pk_mul_f32 v[38:39], v[38:39], v[62:63]
  v_cvt_pk_bf16_f32 v56, v32, v33
  v_cvt_pk_bf16_f32 v57, v34, v35
  v_cvt_pk_bf16_f32 v58, v36, v37
  v_cvt_pk_bf16_f32 v59, v38, v39
  ds_write_b128 v29, v[56:59]
  s_waitcnt lgkmcnt(0)
L_h3j:
  s_barrier
  ds_read_b128 v[96:99], v18 offset:0
  ds_read_b128 v[100:103], v18 offset:128
  ds_read_b128 v[104:107], v18 offset:256
  ds_read_b128 v[108:111], v18 offset:384
  ds_read_b128 v[112:115], v18 offset:512
  ds_read_b128 v[116:119], v18 offset:640
  ds_read_b128 v[120:123], v18 offset:768
  ds_read_b128 v[124:127], v18 offset:896
  s_waitcnt lgkmcnt(7)
  v_smfmac_f32_16x16x64_bf16 v[40:43], v[96:99], v[160:167], v19
  s_waitcnt lgkmcnt(6)
  v_smfmac_f32_16x16x64_bf16 v[44:47], v[100:103], v[168:175], v19
  s_waitcnt lgkmcnt(5)
  v_smfmac_f32_16x16x64_bf16 v[40:43], v[104:107], v[176:183], v19
  s_waitcnt lgkmcnt(4)
  v_smfmac_f32_16x16x64_bf16 v[44:47], v[108:111], v[184:191], v19
  s_waitcnt lgkmcnt(3)
  v_smfmac_f32_16x16x64_bf16 v[40:43], v[112:115], v[192:199], v19
  s_waitcnt lgkmcnt(2)
  v_smfmac_f32_16x16x64_bf16 v[44:47], v[116:119], v[200:207], v19
  s_waitcnt lgkmcnt(1)
  v_smfmac_f32_16x16x64_bf16 v[40:43], v[120:123], v[208:215], v19
  s_waitcnt lgkmcnt(0)
  v_smfmac_f32_16x16x64_bf16 v[44:47], v[124:127], v[216:223], v19
  s_nop 7
  v_pk_add_f32 v[32:33], v[40:41], v[44:45]
  v_add_f32 v32, v32, v33
  v_cvt_pk_bf16_f32 v32, v32, v32
  v_and_b32 v32, 0xffff0000, v32
  v_mul_f32 v34, 0xbfb8aa3b, v32
  v_exp_f32 v34, v34
  v_mov_b32_dpp v33, v32 row_ror:8 row_mask:0xf bank_mask:0xf
  v_add_f32 v34, 1.0, v34
  v_rcp_f32 v34, v34
  s_nop 0
  v_mul_f32 v32, v32, v34
  v_cvt_pk_bf16_f32 v32, v32, v32
  v_and_b32 v32, 0xffff0000, v32
  v_mul_f32 v32, v32, v33
  v_cvt_pk_bf16_f32 v32, v32, v32
  s_mov_b64 exec, 0xff
  ds_write_b16 v25, v32
  s_mov_b64 exec, -1
  s_waitcnt lgkmcnt(0)
  s_barrier
  ds_read_b128 v[32:35], v18 offset:1792
  s_waitcnt lgkmcnt(0)
  v_smfmac_f32_16x16x64_bf16 v[80:83], v[32:35], v[224:231], v19
  v_smfmac_f32_16x16x64_bf16 v[84:87], v[32:35], v[232:239], v19
  v_smfmac_f32_16x16x64_bf16 v[88:91], v[32:35], v[240:247], v19
  v_smfmac_f32_16x16x64_bf16 v[92:95], v[32:35], v[248:255], v19
  s_mov_b64 exec, s[44:45]
  s_nop 3
  v_add_f32 v32, v80, v81
  s_mov_b64 exec, s[46:47]
  v_add_f32 v32, v84, v85
  s_mov_b64 exec, s[48:49]
  v_add_f32 v32, v88, v89
  s_mov_b64 exec, s[50:51]
  v_add_f32 v32, v92, v93
  s_mov_b64 exec, -1
  v_bfi_b32 v32, s39, v13, v32
  s_cmp_eq_u32 s41, 1
  s_cbranch_scc0 L_slow2
  global_store_dword v20, v32, s[12:13]
L_slowret2:
L_hB0:
  s_cmp_lg_u32 s3, 0
  s_cbranch_scc1 L_end
  v_add_u32 v15, 65536, v15
  s_mov_b32 exec_hi, 0xffffff
  global_load_dwordx4 v[64:67], v15, s[12:13] sc1
  global_load_dwordx4 v[68:71], v15, s[12:13] offset:16 sc1
  s_mov_b64 exec, -1
L_hB:
  s_waitcnt vmcnt(0)
  v_xor_b32 v32, s30, v64
  v_xor_b32 v33, s30, v65
  v_xor_b32 v34, s30, v66
  v_xor_b32 v35, s30, v67
  v_xor_b32 v36, s30, v68
  v_xor_b32 v37, s30, v69
  v_xor_b32 v38, s30, v70
  v_xor_b32 v39, s30, v71
  v_or3_b32 v22, v32, v33, v34
  v_or3_b32 v23, v35, v36, v37
  v_or3_b32 v22, v22, v38, v39
  v_bitop3_b32 v22, v22, v23, s39 bitop3:0xa8
  v_cmp_eq_u32 vcc, 0, v22
  s_nop 0
  s_cmp_eq_u64 vcc, -1
  s_cbranch_scc1 L_hB_ok
  s_mov_b32 exec_hi, 0xffffff
  global_load_dwordx4 v[64:67], v15, s[12:13] sc1
  global_load_dwordx4 v[68:71], v15, s[12:13] offset:16 sc1
  s_mov_b64 exec, -1
  s_sub_u32 s31, s31, 1
  s_cmp_lg_u32 s31, 0
  s_cbranch_scc1 L_hB
  s_mov_b32 s31, 1
L_hB_ok:
  v_permlane32_swap_b32 v32, v36
  v_permlane32_swap_b32 v33, v37
  v_permlane32_swap_b32 v34, v38
  v_permlane32_swap_b32 v35, v39
  v_add_f32 v32, v32, v36
  v_add_f32 v33, v33, v37
  v_add_f32 v34, v34, v38
  v_add_f32 v35, v35, v39
  s_nop 0
  v_permlane16_swap_b32 v32, v34
  v_permlane16_swap_b32 v33, v35
  v_add_f32 v32, v32, v34
  v_add_f32 v33, v33, v35
  s_nop 0
  v_add_f32_dpp v34, v32, v32 row_ror:8 row_mask:0xf bank_mask:0x3
  s_nop 1
  v_add_f32_dpp v34, v33, v33 row_ror:8 row_mask:0xf bank_mask:0xc
  s_nop 1
  v_add_f32_dpp v32, v34, v34 row_shl:4 row_mask:0xf bank_mask:0xf
  s_nop 1
  v_add_f32_dpp v33, v32, v32 quad_perm:[2,3,0,1] row_mask:0xf bank_mask:0xf
  v_cvt_pk_bf16_f32 v33, v33, v33
  v_and_b32 v33, 0xffff0000, v33
  v_add_f32 v33, v12, v33
  s_nop 1
  v_mov_b32_dpp v34, v33 row_ror:8 row_mask:0xf bank_mask:0xf
  v_cvt_pk_bf16_f32 v32, v33, v34
  s_mov_b32 exec_lo, 0x30003
  s_mov_b32 exec_hi, 0x30003
  global_store_dword v31, v32, s[62:63]
  s_mov_b64 exec, 1
  s_cmp_lg_u32 s21, 0
  s_cbranch_scc1 L_noepoch
  v_mov_b32 v37, 0
  v_mov_b32 v38, s29
  global_store_dword v37, v38, s[12:13]
L_noepoch:
  s_mov_b64 exec, -1
L_end:
L_done:
  s_endpgm
L_p1f:
  global_store_dwordx4 v28, v[36:39], s[12:13]
  s_branch L_p1r
L_slow0:
  global_store_dword v20, v32, s[12:13] sc1
  s_branch L_slowret0
L_h3w:
  s_cmp_ge_u32 s21, 28
  s_cbranch_scc1 L_end
  v_mov_b32 v80, 0
  v_mov_b32 v81, 0
  v_mov_b32 v82, 0
  v_mov_b32 v83, 0
  v_mov_b32 v84, 0
  v_mov_b32 v85, 0
  v_mov_b32 v86, 0
  v_mov_b32 v87, 0
  v_mov_b32 v88, 0
  v_mov_b32 v89, 0
  v_mov_b32 v90, 0
  v_mov_b32 v91, 0
  v_mov_b32 v92, 0
  v_mov_b32 v93, 0
  v_mov_b32 v94, 0
  v_mov_b32 v95, 0
  v_add_u32 v20, 65536, v20
  s_branch L_h3j
L_slow1:
  global_store_dword v21, v34, s[12:13] sc1
  s_branch L_slowret1
L_slow2:
  global_store_dword v20, v32, s[12:13] sc1
  s_branch L_slowret2
L_tburst:
  s_movk_i32 s34, 3584
  v_mul_lo_u32 v85, v17, s34
  v_lshlrev_b32 v86, 4, v18
  s_cmp_lt_u32 s21, 28
  s_cselect_b32 s66, 1835008, 0
  s_mov_b32 s67, 0x20000
  s_mov_b32 s64, s56
  s_and_b32 s65, s57, 0xffff
  s_mul_i32 s34, s3, 229376
  s_lshl_b32 s35, s21, 7
  s_add_u32 s34, s34, s35
  s_add_u32 s34, s34, 0
  s_lshl_b32 s35, s3, 13
  s_add_u32 s35, s35, 0
  v_xor_b32 v87, 0, v86
  v_add_u32 v87, v85, v87
  s_mov_b32 m0, s35
  s_nop 0
  buffer_load_dwordx4 v87, s[64:67], s34 offen nt lds
  s_add_u32 s34, s34, 28672
  s_add_u32 s35, s35, 1024
  v_xor_b32 v87, 16, v86
  v_add_u32 v87, v85, v87
  s_mov_b32 m0, s35
  s_nop 0
  buffer_load_dwordx4 v87, s[64:67], s34 offen nt lds
  s_add_u32 s34, s34, 28672
  s_add_u32 s35, s35, 1024
  v_xor_b32 v87, 32, v86
  v_add_u32 v87, v85, v87
  s_mov_b32 m0, s35
  s_nop 0
  buffer_load_dwordx4 v87, s[64:67], s34 offen nt lds
  s_add_u32 s34, s34, 28672
  s_add_u32 s35, s35, 1024
  v_xor_b32 v87, 48, v86
  v_add_u32 v87, v85, v87
  s_mov_b32 m0, s35
  s_nop 0
  buffer_load_dwordx4 v87, s[64:67], s34 offen nt lds
  s_add_u32 s34, s34, 28672
  s_add_u32 s35, s35, 1024
  s_branch L_tburstret
L_tailpro:
  s_cmp_lg_u32 s3, 7
  s_cbranch_scc1 L_noreg
  s_lshl_b32 s34, s21, 3
  s_add_u32 s34, s34, 49152
  v_mov_b32 v23, s34
  v_mov_b32 v24, s43
  v_mov_b32 v25, s29
  s_mov_b64 exec, 1
  global_store_dwordx2 v23, v[24:25], s[12:13] sc1
  s_mov_b64 exec, -1
L_noreg:
  s_mov_b32 s64, s56
  s_and_b32 s65, s57, 0xffff
  s_mul_i32 s34, s3, 229376
  s_lshl_b32 s35, s21, 7
  s_add_u32 s34, s34, s35
  s_add_u32 s34, s34, 114688
  s_lshl_b32 s35, s3, 13
  s_add_u32 s35, s35, 4096
  v_xor_b32 v87, 64, v86
  v_add_u32 v87, v85, v87
  s_mov_b32 m0, s35
  s_nop 0
  buffer_load_dwordx4 v87, s[64:67], s34 offen nt lds
  s_add_u32 s34, s34, 28672
  s_add_u32 s35, s35, 1024
  v_xor_b32 v87, 80, v86
  v_add_u32 v87, v85, v87
  s_mov_b32 m0, s35
  s_nop 0
  buffer_load_dwordx4 v87, s[64:67], s34 offen nt lds
  s_add_u32 s34, s34, 28672
  s_add_u32 s35, s35, 1024
  v_xor_b32 v87, 96, v86
  v_add_u32 v87, v85, v87
  s_mov_b32 m0, s35
  s_nop 0
  buffer_load_dwordx4 v87, s[64:67], s34 offen nt lds
  s_add_u32 s34, s34, 28672
  s_add_u32 s35, s35, 1024
  v_xor_b32 v87, 112, v86
  v_add_u32 v87, v85, v87
  s_mov_b32 m0, s35
  s_nop 0
  buffer_load_dwordx4 v87, s[64:67], s34 offen nt lds
  s_add_u32 s34, s34, 28672
  s_add_u32 s35, s35, 1024
  s_waitcnt vmcnt(4)
  s_mov_b32 s64, s58
  s_and_b32 s65, s59, 0xffff
  s_mul_i32 s34, s3, 229376
  s_lshl_b32 s35, s21, 7
  s_add_u32 s34, s34, s35
  s_add_u32 s34, s34, 0
  s_lshl_b32 s35, s3, 13
  s_add_u32 s35, s35, 65536
  v_xor_b32 v87, 0, v86
  v_add_u32 v87, v85, v87
  s_mov_b32 m0, s35
  s_nop 0
  buffer_load_dwordx4 v87, s[64:67], s34 offen nt lds
  s_add_u32 s34, s34, 28672
  s_add_u32 s35, s35, 1024
  v_xor_b32 v87, 16, v86
  v_add_u32 v87, v85, v87
  s_mov_b32 m0, s35
  s_nop 0
  buffer_load_dwordx4 v87, s[64:67], s34 offen nt lds
  s_add_u32 s34, s34, 28672
  s_add_u32 s35, s35, 1024
  v_xor_b32 v87, 32, v86
  v_add_u32 v87, v85, v87
  s_mov_b32 m0, s35
  s_nop 0
  buffer_load_dwordx4 v87, s[64:67], s34 offen nt lds
  s_add_u32 s34, s34, 28672
  s_add_u32 s35, s35, 1024
  v_xor_b32 v87, 48, v86
  v_add_u32 v87, v85, v87
  s_mov_b32 m0, s35
  s_nop 0
  buffer_load_dwordx4 v87, s[64:67], s34 offen nt lds
  s_add_u32 s34, s34, 28672
  s_add_u32 s35, s35, 1024
  v_xor_b32 v87, 64, v86
  v_add_u32 v87, v85, v87
  s_mov_b32 m0, s35
  s_nop 0
  buffer_load_dwordx4 v87, s[64:67], s34 offen nt lds
  s_add_u32 s34, s34, 28672
  s_add_u32 s35, s35, 1024
  v_xor_b32 v87, 80, v86
  v_add_u32 v87, v85, v87
  s_mov_b32 m0, s35
  s_nop 0
  buffer_load_dwordx4 v87, s[64:67], s34 offen nt lds
  s_add_u32 s34, s34, 28672
  s_add_u32 s35, s35, 1024
  v_xor_b32 v87, 96, v86
  v_add_u32 v87, v85, v87
  s_mov_b32 m0, s35
  s_nop 0
  buffer_load_dwordx4 v87, s[64:67], s34 offen nt lds
  s_add_u32 s34, s34, 28672
  s_add_u32 s35, s35, 1024
  v_xor_b32 v87, 112, v86
  v_add_u32 v87, v85, v87
  s_mov_b32 m0, s35
  s_nop 0
  buffer_load_dwordx4 v87, s[64:67], s34 offen nt lds
  s_add_u32 s34, s34, 28672
  s_add_u32 s35, s35, 1024
  s_lshl_b32 s34, s21, 5
  v_and_b32 v19, 1, v1
  v_lshrrev_b32 v20, 5, v1
  v_lshlrev_b32 v19, 3, v19
  v_lshl_add_u32 v19, v20, 2, v19
  v_bfe_u32 v20, v1, 4, 1
  v_lshl_add_u32 v19, v20, 1, v19
  v_bfe_u32 v20, v1, 3, 1
  v_add_u32 v19, v20, v19
  v_lshl_add_u32 v19, v19, 1, s34
  global_load_ushort v12, v19, s[50:51]
  v_lshrrev_b32 v93, 3, v1
  v_and_b32 v19, 7, v1
  v_lshlrev_b32 v93, 10, v93
  v_lshl_add_u32 v93, v19, 4, v93
  v_bfe_u32 v19, v1, 5, 1
  v_lshlrev_b32 v94, 4, v19
  v_bfe_u32 v19, v1, 4, 1
  v_lshl_add_u32 v94, v19, 2, v94
  v_bfe_u32 v19, v1, 2, 1
  v_add_u32 v94, v19, v94
  v_bfe_u32 v19, v1, 3, 1
  v_lshl_add_u32 v94, v19, 3, v94
  v_lshlrev_b32 v94, 7, v94
  s_waitcnt vmcnt(0)
  v_lshlrev_b32 v12, 16, v12
L_tqpoll:
  global_load_dwordx4 v[40:43], v14, s[12:13] sc1
  global_load_dwordx4 v[44:47], v14, s[12:13] offset:16 sc1
  s_waitcnt vmcnt(0)
  v_xor_b32 v16, s29, v41
  v_bitop3_b32 v16, v16, v43, s29 bitop3:0xf6
  v_bitop3_b32 v16, v16, v45, s29 bitop3:0xf6
  v_bitop3_b32 v16, v16, v47, s29 bitop3:0xf6
  v_cmp_eq_u32 vcc, 0, v16
  s_nop 0
  s_cmp_eq_u64 vcc, -1
  s_cbranch_scc1 L_tqpoll_ok
  s_sleep 1
  s_sub_u32 s31, s31, 1
  s_cmp_lg_u32 s31, 0
  s_cbranch_scc1 L_tqpoll
  s_mov_b32 s31, 1
L_tqpoll_ok:
  v_permlane32_swap_b32 v40, v44
  v_permlane32_swap_b32 v42, v46
  v_add_f32 v40, v40, v44
  v_add_f32 v42, v42, v46
  s_nop 1
  v_permlane16_swap_b32 v40, v42
  v_add_f32 v40, v40, v42
  v_cvt_pk_bf16_f32 v40, v40, v40
  ds_write_b16 v15, v40
  s_waitcnt lgkmcnt(0)
  s_barrier
  v_bfe_u32 v17, v1, 5, 1
  v_bfe_u32 v18, v1, 3, 1
  v_lshl_add_u32 v17, v17, 1, v18
  v_xor_b32 v17, s3, v17
  v_lshl_add_u32 v17, v17, 4, v94
  v_and_b32 v18, 1, v1
  v_lshl_add_u32 v17, v18, 3, v17
  v_bfe_u32 v18, v1, 1, 1
  v_lshl_add_u32 v17, v18, 16, v17
  v_xor_b32 v18, 64, v17
  ds_read_b64_tr_b16 v[160:161], v17 offset:0
  ds_read_b64_tr_b16 v[162:163], v17 offset:256
  ds_read_b64_tr_b16 v[164:165], v18 offset:4096
  ds_read_b64_tr_b16 v[166:167], v18 offset:4352
  ds_read_b64_tr_b16 v[168:169], v17 offset:8192
  ds_read_b64_tr_b16 v[170:171], v17 offset:8448
  ds_read_b64_tr_b16 v[172:173], v18 offset:12288
  ds_read_b64_tr_b16 v[174:175], v18 offset:12544
  s_waitcnt lgkmcnt(0)
  ds_read_b64_tr_b16 v[176:177], v17 offset:16384
  ds_read_b64_tr_b16 v[178:179], v17 offset:16640
  ds_read_b64_tr_b16 v[180:181], v18 offset:20480
  ds_read_b64_tr_b16 v[182:183], v18 offset:20736
  ds_read_b64_tr_b16 v[184:185], v17 offset:24576
  ds_read_b64_tr_b16 v[186:187], v17 offset:24832
  ds_read_b64_tr_b16 v[188:189], v18 offset:28672
  ds_read_b64_tr_b16 v[190:191], v18 offset:28928
  s_waitcnt lgkmcnt(0)
  ds_read_b64_tr_b16 v[192:193], v17 offset:32768
  ds_read_b64_tr_b16 v[194:195], v17 offset:33024
  ds_read_b64_tr_b16 v[196:197], v18 offset:36864
  ds_read_b64_tr_b16 v[198:199], v18 offset:37120
  ds_read_b64_tr_b16 v[200:201], v17 offset:40960
  ds_read_b64_tr_b16 v[202:203], v17 offset:41216
  ds_read_b64_tr_b16 v[204:205], v18 offset:45056
  ds_read_b64_tr_b16 v[206:207], v18 offset:45312
  s_waitcnt lgkmcnt(0)
  ds_read_b64_tr_b16 v[208:209], v17 offset:49152
  ds_read_b64_tr_b16 v[210:211], v17 offset:49408
  ds_read_b64_tr_b16 v[212:213], v18 offset:53248
  ds_read_b64_tr_b16 v[214:215], v18 offset:53504
  ds_read_b64_tr_b16 v[216:217], v17 offset:57344
  ds_read_b64_tr_b16 v[218:219], v17 offset:57600
  ds_read_b64_tr_b16 v[220:221], v18 offset:61440
  ds_read_b64_tr_b16 v[222:223], v18 offset:61696
  s_waitcnt lgkmcnt(0)
  s_barrier
  s_mov_b32 s48, s27
  s_add_u32 s49, s48, 4096
  s_and_b32 s49, s49, 0x3fff
  s_or_b32 s49, s49, s28
  s_mov_b32 s64, s52
  s_and_b32 s65, s53, 0xffff
  s_mov_b32 s66, 0x400000
  s_mov_b32 s67, 0x20000
  s_lshl_b32 s46, s21, 17
  s_lshl_b32 s35, s3, 7
  s_add_u32 s46, s46, s35
  s_add_u32 s46, s46, 0
  s_add_u32 m0, s48, 0
  s_nop 0
  buffer_load_dwordx4 v93, s[64:67], s46 offen nt lds
  s_add_u32 s46, s46, 8192
  s_add_u32 m0, s48, 1024
  s_nop 0
  buffer_load_dwordx4 v93, s[64:67], s46 offen nt lds
  s_add_u32 s46, s46, 8192
  s_add_u32 m0, s48, 2048
  s_nop 0
  buffer_load_dwordx4 v93, s[64:67], s46 offen nt lds
  s_add_u32 s46, s46, 8192
  s_add_u32 m0, s48, 3072
  s_nop 0
  buffer_load_dwordx4 v93, s[64:67], s46 offen nt lds
  s_add_u32 s46, s46, 8192
  s_waitcnt vmcnt(0)
  v_and_b32 v19, 3, v1
  v_lshl_add_u32 v19, v19, 3, v94
  v_add_u32 v19, s48, v19
  ds_read_b64_tr_b16 v[96:97], v19 offset:0
  ds_read_b64_tr_b16 v[98:99], v19 offset:256
  ds_read_b64_tr_b16 v[112:113], v19 offset:32
  ds_read_b64_tr_b16 v[114:115], v19 offset:288
  ds_read_b64_tr_b16 v[128:129], v19 offset:64
  ds_read_b64_tr_b16 v[130:131], v19 offset:320
  ds_read_b64_tr_b16 v[144:145], v19 offset:96
  ds_read_b64_tr_b16 v[146:147], v19 offset:352
  s_waitcnt lgkmcnt(0)
  s_cmp_lt_u32 s24, 48
  s_cselect_b32 s35, s15, 0
  s_add_u32 s36, s35, s14
  s_sub_u32 s35, s24, 48
  s_cmp_lt_u32 s35, s15
  s_cselect_b32 s35, s40, s25
  s_cselect_b32 s36, s17, s36
  s_add_u32 s34, s24, s36
  s_and_b32 s34, s34, 127
  s_lshl_b32 s34, s34, 12
  s_add_u32 s34, s34, s35
  s_mov_b32 m0, s27
  s_nop 0
  buffer_load_dwordx4 v3, s[4:7], s34 offen offset:0 nt lds
  buffer_load_dwordx4 v4, s[4:7], s34 offen offset:1024 nt lds
  buffer_load_dwordx4 v5, s[4:7], s34 offen offset:2048 nt lds
  buffer_load_dwordx4 v6, s[4:7], s34 offen offset:3072 nt lds
  s_add_u32 s24, s24, 8
  s_add_u32 s27, s27, 4096
  s_and_b32 s27, s27, 0x3fff
  s_or_b32 s27, s27, s28
  s_cmp_lt_u32 s24, 48
  s_cselect_b32 s35, s15, 0
  s_add_u32 s36, s35, s14
  s_sub_u32 s35, s24, 48
  s_cmp_lt_u32 s35, s15
  s_cselect_b32 s35, s40, s25
  s_cselect_b32 s36, s17, s36
  s_add_u32 s34, s24, s36
  s_and_b32 s34, s34, 127
  s_lshl_b32 s34, s34, 12
  s_add_u32 s34, s34, s35
  s_mov_b32 m0, s27
  s_nop 0
  buffer_load_dwordx4 v3, s[4:7], s34 offen offset:0 nt lds
  buffer_load_dwordx4 v4, s[4:7], s34 offen offset:1024 nt lds
  buffer_load_dwordx4 v5, s[4:7], s34 offen offset:2048 nt lds
  buffer_load_dwordx4 v6, s[4:7], s34 offen offset:3072 nt lds
  s_add_u32 s24, s24, 8
  s_add_u32 s27, s27, 4096
  s_and_b32 s27, s27, 0x3fff
  s_or_b32 s27, s27, s28
  s_cmp_lt_u32 s24, 48
  s_cselect_b32 s35, s15, 0
  s_add_u32 s36, s35, s14
  s_sub_u32 s35, s24, 48
  s_cmp_lt_u32 s35, s15
  s_cselect_b32 s35, s40, s25
  s_cselect_b32 s36, s17, s36
  s_add_u32 s34, s24, s36
  s_and_b32 s34, s34, 127
  s_lshl_b32 s34, s34, 12
  s_add_u32 s34, s34, s35
  s_mov_b32 m0, s27
  s_nop 0
  buffer_load_dwordx4 v3, s[4:7], s34 offen offset:0 nt lds
  buffer_load_dwordx4 v4, s[4:7], s34 offen offset:1024 nt lds
  buffer_load_dwordx4 v5, s[4:7], s34 offen offset:2048 nt lds
  buffer_load_dwordx4 v6, s[4:7], s34 offen offset:3072 nt lds
  s_add_u32 s24, s24, 8
  s_add_u32 s27, s27, 4096
  s_and_b32 s27, s27, 0x3fff
  s_or_b32 s27, s27, s28
  s_cmp_lt_u32 s24, 48
  s_cselect_b32 s35, s15, 0
  s_add_u32 s36, s35, s14
  s_sub_u32 s35, s24, 48
  s_cmp_lt_u32 s35, s15
  s_cselect_b32 s35, s40, s25
  s_cselect_b32 s36, s17, s36
  s_add_u32 s34, s24, s36
  s_and_b32 s34, s34, 127
  s_lshl_b32 s34, s34, 12
  s_add_u32 s34, s34, s35
  s_mov_b32 m0, s27
  s_nop 0
  buffer_load_dwordx4 v3, s[4:7], s34 offen offset:0 nt lds
  buffer_load_dwordx4 v4, s[4:7], s34 offen offset:1024 nt lds
  buffer_load_dwordx4 v5, s[4:7], s34 offen offset:2048 nt lds
  buffer_load_dwordx4 v6, s[4:7], s34 offen offset:3072 nt lds
  s_add_u32 s24, s24, 8
  s_add_u32 s27, s27, 4096
  s_and_b32 s27, s27, 0x3fff
  s_or_b32 s27, s27, s28
  s_branch L_qops
L_ps1q:
  s_waitcnt vmcnt(5)
  s_cmp_lt_u32 s24, 48
  s_cselect_b32 s35, s15, 0
  s_add_u32 s36, s35, s14
  s_sub_u32 s35, s24, 48
  s_cmp_lt_u32 s35, s15
  s_cselect_b32 s35, s40, s25
  s_cselect_b32 s36, s17, s36
  s_add_u32 s34, s24, s36
  s_and_b32 s34, s34, 127
  s_lshl_b32 s34, s34, 12
  s_add_u32 s34, s34, s35
  s_mov_b32 m0, s27
  s_nop 0
  buffer_load_dwordx4 v3, s[4:7], s34 offen offset:0 nt lds
  buffer_load_dwordx4 v4, s[4:7], s34 offen offset:1024 nt lds
  buffer_load_dwordx4 v5, s[4:7], s34 offen offset:2048 nt lds
  buffer_load_dwordx4 v6, s[4:7], s34 offen offset:3072 nt lds
  s_add_u32 s24, s24, 8
  s_add_u32 s27, s27, 4096
  s_and_b32 s27, s27, 0x3fff
  s_or_b32 s27, s27, s28
  s_waitcnt vmcnt(4)
  v_xor_b32 v16, s29, v41
  v_bitop3_b32 v16, v16, v43, s29 bitop3:0xf6
  v_bitop3_b32 v16, v16, v45, s29 bitop3:0xf6
  v_bitop3_b32 v16, v16, v47, s29 bitop3:0xf6
  v_cmp_eq_u32 vcc, 0, v16
  s_nop 0
  s_cmp_eq_u64 vcc, -1
  s_cselect_b32 s55, 2, 0
  s_cbranch_scc0 L_ps1r
  v_permlane32_swap_b32 v40, v44
  v_permlane32_swap_b32 v42, v46
  v_add_f32 v40, v40, v44
  v_add_f32 v42, v42, v46
  s_nop 1
  v_permlane16_swap_b32 v40, v42
  v_add_f32 v40, v40, v42
  v_cvt_pk_bf16_f32 v40, v40, v40
  ds_write_b16 v15, v40
  s_branch L_ps1r
L_ps2q:
  s_waitcnt vmcnt(5)
  s_cmp_lt_u32 s24, 48
  s_cselect_b32 s35, s15, 0
  s_add_u32 s36, s35, s14
  s_sub_u32 s35, s24, 48
  s_cmp_lt_u32 s35, s15
  s_cselect_b32 s35, s40, s25
  s_cselect_b32 s36, s17, s36
  s_add_u32 s34, s24, s36
  s_and_b32 s34, s34, 127
  s_lshl_b32 s34, s34, 12
  s_add_u32 s34, s34, s35
  s_mov_b32 m0, s27
  s_nop 0
  buffer_load_dwordx4 v3, s[4:7], s34 offen offset:0 nt lds
  buffer_load_dwordx4 v4, s[4:7], s34 offen offset:1024 nt lds
  buffer_load_dwordx4 v5, s[4:7], s34 offen offset:2048 nt lds
  buffer_load_dwordx4 v6, s[4:7], s34 offen offset:3072 nt lds
  s_add_u32 s24, s24, 8
  s_add_u32 s27, s27, 4096
  s_and_b32 s27, s27, 0x3fff
  s_or_b32 s27, s27, s28
  s_waitcnt vmcnt(4)
  v_xor_b32 v16, s29, v41
  v_bitop3_b32 v16, v16, v43, s29 bitop3:0xf6
  v_bitop3_b32 v16, v16, v45, s29 bitop3:0xf6
  v_bitop3_b32 v16, v16, v47, s29 bitop3:0xf6
  v_cmp_eq_u32 vcc, 0, v16
  s_nop 0
  s_cmp_eq_u64 vcc, -1
  s_cselect_b32 s55, 2, 0
  s_cbranch_scc0 L_ps2r
  v_permlane32_swap_b32 v40, v44
  v_permlane32_swap_b32 v42, v46
  v_add_f32 v40, v40, v44
  v_add_f32 v42, v42, v46
  s_nop 1
  v_permlane16_swap_b32 v40, v42
  v_add_f32 v40, v40, v42
  v_cvt_pk_bf16_f32 v40, v40, v40
  ds_write_b16 v15, v40
  s_branch L_ps2r
L_ps3q:
  s_waitcnt vmcnt(5)
  s_cmp_lt_u32 s24, 48
  s_cselect_b32 s35, s15, 0
  s_add_u32 s36, s35, s14
  s_sub_u32 s35, s24, 48
  s_cmp_lt_u32 s35, s15
  s_cselect_b32 s35, s40, s25
  s_cselect_b32 s36, s17, s36
  s_add_u32 s34, s24, s36
  s_and_b32 s34, s34, 127
  s_lshl_b32 s34, s34, 12
  s_add_u32 s34, s34, s35
  s_mov_b32 m0, s27
  s_nop 0
  buffer_load_dwordx4 v3, s[4:7], s34 offen offset:0 nt lds
  buffer_load_dwordx4 v4, s[4:7], s34 offen offset:1024 nt lds
  buffer_load_dwordx4 v5, s[4:7], s34 offen offset:2048 nt lds
  buffer_load_dwordx4 v6, s[4:7], s34 offen offset:3072 nt lds
  s_add_u32 s24, s24, 8
  s_add_u32 s27, s27, 4096
  s_and_b32 s27, s27, 0x3fff
  s_or_b32 s27, s27, s28
  s_waitcnt vmcnt(4)
  v_xor_b32 v16, s29, v41
  v_bitop3_b32 v16, v16, v43, s29 bitop3:0xf6
  v_bitop3_b32 v16, v16, v45, s29 bitop3:0xf6
  v_bitop3_b32 v16, v16, v47, s29 bitop3:0xf6
  v_cmp_eq_u32 vcc, 0, v16
  s_nop 0
  s_cmp_eq_u64 vcc, -1
  s_cselect_b32 s55, 2, 0
  s_cbranch_scc0 L_ps3r
  v_permlane32_swap_b32 v40, v44
  v_permlane32_swap_b32 v42, v46
  v_add_f32 v40, v40, v44
  v_add_f32 v42, v42, v46
  s_nop 1
  v_permlane16_swap_b32 v40, v42
  v_add_f32 v40, v40, v42
  v_cvt_pk_bf16_f32 v40, v40, v40
  ds_write_b16 v15, v40
  s_branch L_ps3r
L_isV0:
  s_sub_u32 s34, s33, s22
  s_cmp_lt_u32 s34, 48
  s_cselect_b32 s35, s15, 0
  s_add_u32 s36, s35, s14
  s_sub_u32 s35, s34, 48
  s_cmp_lt_u32 s35, s15
  s_cselect_b32 s35, s40, s25
  s_cselect_b32 s36, s17, s36
  s_add_u32 s34, s34, s36
  s_and_b32 s34, s34, 127
  s_lshl_b32 s34, s34, 12
  s_add_u32 s34, s34, s35
  s_mov_b32 m0, s27
  s_waitcnt vmcnt(0)
  buffer_load_dwordx4 v7, s[8:11], s34 offen offset:0 nt lds
  buffer_load_dwordx4 v7, s[8:11], s34 offen offset:1024 nt lds
  buffer_load_dwordx4 v7, s[8:11], s34 offen offset:2048 nt lds
  buffer_load_dwordx4 v7, s[8:11], s34 offen offset:3072 nt lds
  s_branch L_isret0
L_wB:
  s_mov_b32 s48, s27
  s_add_u32 s49, s48, 4096
  s_and_b32 s49, s49, 0x3fff
  s_or_b32 s49, s49, s28
  s_mov_b32 s64, s52
  s_and_b32 s65, s53, 0xffff
  s_mov_b32 s66, 0x400000
  s_mov_b32 s67, 0x20000
  s_lshl_b32 s46, s21, 17
  s_lshl_b32 s35, s3, 7
  s_add_u32 s46, s46, s35
  s_add_u32 s46, s46, 32768
  s_add_u32 m0, s48, 0
  s_nop 0
  buffer_load_dwordx4 v93, s[64:67], s46 offen nt lds
  s_add_u32 s46, s46, 8192
  s_add_u32 m0, s48, 1024
  s_nop 0
  buffer_load_dwordx4 v93, s[64:67], s46 offen nt lds
  s_add_u32 s46, s46, 8192
  s_add_u32 m0, s48, 2048
  s_nop 0
  buffer_load_dwordx4 v93, s[64:67], s46 offen nt lds
  s_add_u32 s46, s46, 8192
  s_add_u32 m0, s48, 3072
  s_nop 0
  buffer_load_dwordx4 v93, s[64:67], s46 offen nt lds
  s_add_u32 s46, s46, 8192
  s_add_u32 m0, s49, 0
  s_nop 0
  buffer_load_dwordx4 v93, s[64:67], s46 offen nt lds
  s_add_u32 s46, s46, 8192
  s_add_u32 m0, s49, 1024
  s_nop 0
  buffer_load_dwordx4 v93, s[64:67], s46 offen nt lds
  s_add_u32 s46, s46, 8192
  s_add_u32 m0, s49, 2048
  s_nop 0
  buffer_load_dwordx4 v93, s[64:67], s46 offen nt lds
  s_add_u32 s46, s46, 8192
  s_add_u32 m0, s49, 3072
  s_nop 0
  buffer_load_dwordx4 v93, s[64:67], s46 offen nt lds
  s_add_u32 s46, s46, 8192
  s_waitcnt vmcnt(4)
  v_and_b32 v19, 3, v1
  v_lshl_add_u32 v19, v19, 3, v94
  v_add_u32 v19, s48, v19
  ds_read_b64_tr_b16 v[100:101], v19 offset:0
  ds_read_b64_tr_b16 v[102:103], v19 offset:256
  ds_read_b64_tr_b16 v[116:117], v19 offset:32
  ds_read_b64_tr_b16 v[118:119], v19 offset:288
  ds_read_b64_tr_b16 v[132:133], v19 offset:64
  ds_read_b64_tr_b16 v[134:135], v19 offset:320
  ds_read_b64_tr_b16 v[148:149], v19 offset:96
  ds_read_b64_tr_b16 v[150:151], v19 offset:352
  s_waitcnt lgkmcnt(0)
  s_add_u32 m0, s48, 0
  s_nop 0
  buffer_load_dwordx4 v93, s[64:67], s46 offen nt lds
  s_add_u32 s46, s46, 8192
  s_add_u32 m0, s48, 1024
  s_nop 0
  buffer_load_dwordx4 v93, s[64:67], s46 offen nt lds
  s_add_u32 s46, s46, 8192
  s_add_u32 m0, s48, 2048
  s_nop 0
  buffer_load_dwordx4 v93, s[64:67], s46 offen nt lds
  s_add_u32 s46, s46, 8192
  s_add_u32 m0, s48, 3072
  s_nop 0
  buffer_load_dwordx4 v93, s[64:67], s46 offen nt lds
  s_add_u32 s46, s46, 8192
  s_waitcnt vmcnt(4)
  v_and_b32 v19, 3, v1
  v_lshl_add_u32 v19, v19, 3, v94
  v_add_u32 v19, s49, v19
  ds_read_b64_tr_b16 v[104:105], v19 offset:0
  ds_read_b64_tr_b16 v[106:107], v19 offset:256
  ds_read_b64_tr_b16 v[120:121], v19 offset:32
  ds_read_b64_tr_b16 v[122:123], v19 offset:288
  ds_read_b64_tr_b16 v[136:137], v19 offset:64
  ds_read_b64_tr_b16 v[138:139], v19 offset:320
  ds_read_b64_tr_b16 v[152:153], v19 offset:96
  ds_read_b64_tr_b16 v[154:155], v19 offset:352
  s_waitcnt lgkmcnt(0)
  s_mov_b32 s64, s60
  s_and_b32 s65, s61, 0xffff
  s_mov_b32 s66, 1835008
  s_mov_b32 s67, 0x20000
  s_lshl_b32 s46, s21, 16
  s_lshl_b32 s35, s3, 7
  s_add_u32 s46, s46, s35
  s_add_u32 s46, s46, 0
  s_add_u32 m0, s49, 0
  s_nop 0
  buffer_load_dwordx4 v93, s[64:67], s46 offen nt lds
  s_add_u32 s46, s46, 8192
  s_add_u32 m0, s49, 1024
  s_nop 0
  buffer_load_dwordx4 v93, s[64:67], s46 offen nt lds
  s_add_u32 s46, s46, 8192
  s_add_u32 m0, s49, 2048
  s_nop 0
  buffer_load_dwordx4 v93, s[64:67], s46 offen nt lds
  s_add_u32 s46, s46, 8192
  s_add_u32 m0, s49, 3072
  s_nop 0
  buffer_load_dwordx4 v93, s[64:67], s46 offen nt lds
  s_add_u32 s46, s46, 8192
  s_waitcnt vmcnt(4)
  v_and_b32 v19, 3, v1
  v_lshl_add_u32 v19, v19, 3, v94
  v_add_u32 v19, s48, v19
  ds_read_b64_tr_b16 v[108:109], v19 offset:0
  ds_read_b64_tr_b16 v[110:111], v19 offset:256
  ds_read_b64_tr_b16 v[124:125], v19 offset:32
  ds_read_b64_tr_b16 v[126:127], v19 offset:288
  ds_read_b64_tr_b16 v[140:141], v19 offset:64
  ds_read_b64_tr_b16 v[142:143], v19 offset:320
  ds_read_b64_tr_b16 v[156:157], v19 offset:96
  ds_read_b64_tr_b16 v[158:159], v19 offset:352
  s_waitcnt lgkmcnt(0)
  s_add_u32 m0, s48, 0
  s_nop 0
  buffer_load_dwordx4 v93, s[64:67], s46 offen nt lds
  s_add_u32 s46, s46, 8192
  s_add_u32 m0, s48, 1024
  s_nop 0
  buffer_load_dwordx4 v93, s[64:67], s46 offen nt lds
  s_add_u32 s46, s46, 8192
  s_add_u32 m0, s48, 2048
  s_nop 0
  buffer_load_dwordx4 v93, s[64:67], s46 offen nt lds
  s_add_u32 s46, s46, 8192
  s_add_u32 m0, s48, 3072
  s_nop 0
  buffer_load_dwordx4 v93, s[64:67], s46 offen nt lds
  s_add_u32 s46, s46, 8192
  s_waitcnt vmcnt(4)
  v_and_b32 v19, 3, v1
  v_lshl_add_u32 v19, v19, 3, v94
  v_add_u32 v19, s49, v19
  ds_read_b64_tr_b16 v[224:225], v19 offset:0
  ds_read_b64_tr_b16 v[226:227], v19 offset:256
  ds_read_b64_tr_b16 v[232:233], v19 offset:32
  ds_read_b64_tr_b16 v[234:235], v19 offset:288
  ds_read_b64_tr_b16 v[240:241], v19 offset:64
  ds_read_b64_tr_b16 v[242:243], v19 offset:320
  ds_read_b64_tr_b16 v[248:249], v19 offset:96
  ds_read_b64_tr_b16 v[250:251], v19 offset:352
  s_waitcnt lgkmcnt(0)
  s_waitcnt vmcnt(0)
  v_and_b32 v19, 3, v1
  v_lshl_add_u32 v19, v19, 3, v94
  v_add_u32 v19, s48, v19
  ds_read_b64_tr_b16 v[228:229], v19 offset:0
  ds_read_b64_tr_b16 v[230:231], v19 offset:256
  ds_read_b64_tr_b16 v[236:237], v19 offset:32
  ds_read_b64_tr_b16 v[238:239], v19 offset:288
  ds_read_b64_tr_b16 v[244:245], v19 offset:64
  ds_read_b64_tr_b16 v[246:247], v19 offset:320
  ds_read_b64_tr_b16 v[252:253], v19 offset:96
  ds_read_b64_tr_b16 v[254:255], v19 offset:352
  s_waitcnt lgkmcnt(0)
  s_branch L_wBret
L_gather:
  s_mov_b32 s42, -1
  s_lshl_b32 s34, s18, 11
  s_add_u32 s34, s34, 32768
  v_add_u32 v18, s34, v2
  s_getpc_b64 s[44:45]
L_pc2:
  s_sub_u32 s44, s44, L_pc2-L_vloop
  s_subb_u32 s45, s45, 0
  v_mov_b32 v21, v2
  global_load_dwordx4 v[88:91], v21, s[44:45]
  v_add_u32 v21, 1024, v21
  global_load_dwordx4 v[88:91], v21, s[44:45]
  v_add_u32 v21, 1024, v21
  global_load_dwordx4 v[88:91], v21, s[44:45]
  v_add_u32 v21, 1024, v21
  global_load_dwordx4 v[88:91], v21, s[44:45]
  v_add_u32 v21, 1024, v21
L_gpoll:
  global_load_dwordx4 v[80:83], v18, s[12:13] sc1
  global_load_dwordx4 v[84:87], v18, s[12:13] offset:1024 sc1
  s_waitcnt vmcnt(0)
  v_xor_b32 v21, s29, v81
  v_bitop3_b32 v21, v21, v83, s29 bitop3:0xf6
  v_bitop3_b32 v21, v21, v85, s29 bitop3:0xf6
  v_bitop3_b32 v21, v21, v87, s29 bitop3:0xf6
  v_cmp_eq_u32 vcc, 0, v21
  s_nop 0
  s_cmp_eq_u64 vcc, -1
  s_cbranch_scc1 L_gpoll_ok
  s_sleep 1
  s_sub_u32 s31, s31, 1
  s_cmp_lg_u32 s31, 0
  s_cbranch_scc1 L_gpoll
  s_mov_b32 s31, 1
L_gpoll_ok:
  v_max_f32 v22, v80, v84
  s_nop 1
  v_max_f32_dpp v22, v22, v22 row_ror:4 row_mask:0xf bank_mask:0xf
  s_nop 1
  v_max_f32_dpp v22, v22, v22 row_ror:8 row_mask:0xf bank_mask:0xf
  v_mov_b32 v21, v22
  s_nop 1
  v_permlane16_swap_b32 v22, v21
  v_max_f32 v22, v22, v21
  v_mov_b32 v21, v22
  s_nop 1
  v_permlane32_swap_b32 v22, v21
  v_max_f32 v22, v22, v21
  v_sub_f32 v80, v80, v22
  v_sub_f32 v84, v84, v22
  v_sub_f32 v88, v29, v22
  v_mul_f32 v80, 0x3fb8aa3b, v80
  v_mul_f32 v84, 0x3fb8aa3b, v84
  v_mul_f32 v88, 0x3fb8aa3b, v88
  v_exp_f32 v80, v80
  v_exp_f32 v84, v84
  v_exp_f32 v88, v88
  v_mul_f32 v23, v80, v82
  v_fmac_f32 v23, v84, v86
  s_nop 1
  v_add_f32_dpp v23, v23, v23 row_ror:4 row_mask:0xf bank_mask:0xf
  s_nop 1
  v_add_f32_dpp v23, v23, v23 row_ror:8 row_mask:0xf bank_mask:0xf
  v_mov_b32 v21, v23
  s_nop 1
  v_permlane16_swap_b32 v23, v21
  v_add_f32 v23, v23, v21
  v_mov_b32 v21, v23
  s_nop 1
  v_permlane32_swap_b32 v23, v21
  v_add_f32 v23, v23, v21
  v_rcp_f32 v90, v23
  s_nop 0
  v_mul_f32 v90, v90, v88
  v_mov_b32 v91, 0
  s_cmp_eq_u32 s20, 0
  s_cbranch_scc1 L_gfin
  v_and_b32 v19, 31, v1
  v_lshlrev_b32 v19, 3, v19
  v_add_u32 v19, 49152, v19
L_rpoll:
  global_load_dwordx2 v[80:81], v19, s[12:13] sc1
  s_waitcnt vmcnt(0)
  v_cmp_eq_u32 vcc, s29, v81
  s_nop 0
  s_cmp_eq_u64 vcc, -1
  s_cbranch_scc1 L_rpoll_ok
  s_sleep 1
  s_sub_u32 s31, s31, 1
  s_cmp_lg_u32 s31, 0
  s_cbranch_scc1 L_rpoll
  s_mov_b32 s31, 1
L_rpoll_ok:
  v_cmp_eq_u32 vcc, s43, v80
  s_nop 0
  s_cmp_eq_u64 vcc, -1
  s_cselect_b32 s34, 1, 0
  v_mov_b32 v91, s34
L_gfin:
  v_add_u32 v21, 152832, v2
  s_mov_b64 exec, 0xf
  ds_write_b128 v21, v[88:91]
  s_mov_b64 exec, -1
  s_branch L_gatherret
L_codeend:
.section .rodata,"a"
.p2align 6
.amdhsa_kernel sequential_preLN__gqa_block_cached__glu_gated_swiglu__decode_kernel
  .amdhsa_next_free_vgpr 256
  .amdhsa_next_free_sgpr 102
  .amdhsa_accum_offset 256
  .amdhsa_group_segment_fixed_size 0
  .amdhsa_kernarg_size 96
  .amdhsa_user_sgpr_count 2
  .amdhsa_user_sgpr_kernarg_segment_ptr 1
  .amdhsa_system_sgpr_workgroup_id_x 1
  .amdhsa_float_denorm_mode_32 3
.end_amdhsa_kernel
```
